```python
import torch

def _softmax(x, axis=-1):
    return torch.softmax(x, dim=axis)
def _gelu(x):
    return torch.nn.functional.gelu(x, approximate="tanh")
def _silu(x):
    return torch.nn.functional.silu(x)
def _sigmoid(x):
    return torch.sigmoid(x)
def _layernorm(x, axis=-1, eps=1e-5):
    m = x.mean(dim=axis, keepdim=True)
    v = x.var(dim=axis, keepdim=True, unbiased=False)
    return (x - m) / torch.sqrt(v + eps)
def _scatter_add(tgt, idx, src, axis=0):
    return tgt.clone().index_add_(axis, idx, src)
def _segment_sum(src, seg, n):
    out = torch.zeros((n,) + src.shape[1:], dtype=src.dtype)
    return out.index_add_(0, seg, src)
def _pad(x, pw):
    flat = tuple(v for pair in reversed(pw) for v in pair)
    return torch.nn.functional.pad(x, flat)

kernel_name = 'recurrent_scan__sliding_local_dilated__glu_gated_bilinear__prompt'

def setup_inputs():

    _w = (lambda a: (lambda t: t.to(torch.bfloat16) if t.is_floating_point() else t)(torch.as_tensor(a)))
    def _A_setup():
        B, S, D = 1, 2048, 448
        return {
            "x": _w((lambda *s: torch.randn(*s, dtype=torch.bfloat16) * 0.05)(B, S, D)),
            "wqkv": _w((lambda *s: torch.randn(*s, dtype=torch.bfloat16) * 0.2)(D, 3 * D)),
            "wo": _w((lambda *s: torch.randn(*s, dtype=torch.bfloat16) * 0.2)(D, D)),
        }
    _A_in = _A_setup()

    def _B_setup():
        B, S, D, F = 1, 2048, 448, 1792
        return {
            "x": _w((lambda *s: torch.randn(*s, dtype=torch.bfloat16) * 0.05)(B, S, D)),
            "w_gate": _w((lambda *s: torch.randn(*s, dtype=torch.bfloat16) * 0.1)(D, F) * (D ** -0.5)),
            "w_up": _w((lambda *s: torch.randn(*s, dtype=torch.bfloat16) * 0.1)(D, F) * (D ** -0.5)),
            "w_down": _w((lambda *s: torch.randn(*s, dtype=torch.bfloat16) * 0.1)(F, D) * (F ** -0.5)),
        }
    _B_in = _B_setup()

    return {
        "A_x": _A_in["x"],
        "A_wqkv": _A_in["wqkv"],
        "A_wo": _A_in["wo"],
        "B_x": _B_in["x"],
        "B_w_gate": _B_in["w_gate"],
        "B_w_up": _B_in["w_up"],
        "B_w_down": _B_in["w_down"],
    }

def reference(A_x, A_wqkv, A_wo, B_x, B_w_gate, B_w_up, B_w_down):
    def _A_ref(x, wqkv, wo):
        B, S, D = x.shape
        H = 16; Dh = D // H
        W, dil = 8, 2
        qkv = (lambda x, *d: x.permute(*d))((x @ wqkv).reshape(B, S, 3, H, Dh), 2, 0, 3, 1, 4)
        q, k, v = qkv[0], qkv[1], qkv[2]
        scale = Dh ** -0.5
        pos = torch.arange(S)
        off = torch.arange(W) * dil
        idx = pos[:, None] - off[None, :]
        mask = idx >= 0
        idx_c = torch.where(mask, idx, 0).reshape(-1)
        kg = k[:, :, idx_c, :].reshape(B, H, S, W, Dh)
        vg = v[:, :, idx_c, :].reshape(B, H, S, W, Dh)
        logits = torch.einsum("bhsd,bhswd->bhsw", q, kg) * scale
        logits = torch.where(mask[None, None, :, :], logits, -1e9)
        attn = _softmax(logits, axis=-1)
        o = torch.einsum("bhsw,bhswd->bhsd", attn, vg)
        return (lambda x, *d: x.permute(*d))(o, 0, 2, 1, 3).reshape(B, S, D) @ wo

    def _B_ref(x, w_gate, w_up, w_down):
        g = torch.einsum("bsd,df->bsf", x, w_gate)
        u = torch.einsum("bsd,df->bsf", x, w_up)
        h = g * u
        return torch.einsum("bsf,fd->bsd", h, w_down)

    x = A_x
    xn = _layernorm(x, axis=-1)
    s = _A_ref(xn, A_wqkv, A_wo)
    g = _silu(_B_ref(xn, B_w_gate, B_w_up, B_w_down))
    return x + s * g
```

```asm
; @launch grid=(256,1,1) block=(512,1,1) lds=163840
.amdgcn_target "amdgcn-amd-amdhsa--gfx950"
.text
.globl recurrent_scan__sliding_local_dilated__glu_gated_bilinear__prompt_kernel
.p2align 8
.type recurrent_scan__sliding_local_dilated__glu_gated_bilinear__prompt_kernel,@function
recurrent_scan__sliding_local_dilated__glu_gated_bilinear__prompt_kernel:
    s_cmp_ge_u32 s2, 256
    s_cbranch_scc1 K_EXIT
    s_load_dwordx4 s[4:7], s[0:1], 0
    s_load_dwordx4 s[8:11], s[0:1], 32
    s_load_dwordx4 s[68:71], s[0:1], 48
    s_load_dwordx4 s[72:75], s[0:1], 64
    s_load_dwordx2 s[76:77], s[0:1], 16
    v_lshrrev_b32 v1, 6, v0
    v_and_b32 v0, 63, v0
    v_readfirstlane_b32 s14, v1
    s_and_b32 s3, s2, 7
    s_lshr_b32 s2, s2, 3
    s_nop 1
    v_and_b32 v1, 15, v0
    s_lshl_b32 s40, s2, 1
    s_add_u32 s40, s40, s14
    s_sub_u32 s40, s40, 60
    s_and_b32 s41, s14, 6
    s_cmp_lg_u32 s41, 2
    s_cbranch_scc1 K_NOCODE
    s_cmp_lt_u32 s2, 29
    s_cbranch_scc1 K_NOCODE
    s_lshl_b32 s40, s40, 13
    s_getpc_b64 s[16:17]
K_PC:
    s_sub_u32 s16, s16, K_PC - recurrent_scan__sliding_local_dilated__glu_gated_bilinear__prompt_kernel
    s_subb_u32 s17, s17, 0
    s_mov_b32 s18, CODE_END - recurrent_scan__sliding_local_dilated__glu_gated_bilinear__prompt_kernel
    s_mov_b32 s19, 0x00020000
    s_mov_b32 m0, 157712
    v_lshlrev_b32 v2, 7, v0
    buffer_load_dword v2, s[16:19], s40 offen lds
K_NOCODE:
    s_cmp_eq_u32 s3, 7
    s_cselect_b32 s15, 0, s3
    v_lshrrev_b32 v2, 4, v0
    s_mov_b32 s32, 0xffff0000
    s_and_b32 s33, s14, 3
    s_and_b32 s78, s2, 3
    s_lshl_b32 s79, s3, 2
    s_add_u32 s78, s78, s79
    s_lshr_b32 s79, s2, 2
    s_cmp_eq_u32 s2, 28
    s_cselect_b32 s78, 32, s78
    s_cselect_b32 s79, s3, s79
    s_cmp_ge_u32 s14, 4
    s_cbranch_scc1 K_ROLE
    s_waitcnt lgkmcnt(0)
    v_mov_b32 v14, 0
    s_or_b32 s40, s2, s3
    s_or_b32 s40, s40, s14
    s_cmp_lg_u32 s40, 0
    s_cbranch_scc1 G_NOTAG
    s_memrealtime s[40:41]
    s_waitcnt lgkmcnt(0)
    s_or_b32 s40, s40, 1
    v_mov_b32 v15, s40
    s_mov_b64 exec, 1
    global_store_dword v14, v15, s[72:73] sc1
    s_mov_b64 exec, -1
G_NOTAG:
    s_mov_b32 s16, s4
    s_mov_b32 s17, s5
    s_mov_b32 s18, 1835008
    s_mov_b32 s19, 0x00020000
    s_lshl_b32 s40, s2, 3
    s_add_u32 s40, s40, s3
    s_lshl_b32 s40, s40, 2
    s_add_u32 s40, s40, s33
    s_mul_i32 s40, s40, 1792
    v_and_b32 v16, 31, v0
    v_cmp_gt_u32 vcc, 28, v16
    v_lshrrev_b32 v17, 5, v0
    v_mul_u32_u24 v17, 896, v17
    v_lshl_add_u32 v16, v16, 5, v17
    v_mov_b32 v17, 1073741824
    v_cndmask_b32 v16, v17, v16, vcc
    buffer_load_dwordx4 v[32:35], v16, s[16:19], s40 offen
    buffer_load_dwordx4 v[36:39], v16, s[16:19], s40 offen offset:16
K_ROLE:
    s_cmp_ge_u32 s2, 21
    s_cbranch_scc1 K_QKV
    s_mul_i32 s40, s3, 21
    s_add_u32 s40, s40, s2
    s_mul_i32 s48, s40, 171
    s_lshr_b32 s48, s48, 11
    s_mul_i32 s41, s48, 12
    s_sub_u32 s40, s40, s41
    s_mul_i32 s49, s40, 175
    s_mul_i32 s54, s40, 630784
    s_mov_b32 s55, s40
    s_lshl_b32 s38, s40, 5
    s_add_u32 s38, s38, s48
    s_lshl_b32 s38, s38, 2
    s_mov_b32 s13, 0
    s_cmp_lt_u32 s14, 4
    s_cbranch_scc1 G_COMPUTE
    v_lshrrev_b32 v3, 3, v0
    v_and_b32 v4, 7, v0
    s_and_b32 s40, s33, 1
    s_lshl_b32 s40, s40, 2
    v_add_u32 v6, s40, v2
    v_xor_b32 v6, v6, v4
    v_lshlrev_b32 v6, 4, v6
    v_mul_u32_u24 v5, 896, v3
    v_add_u32 v5, v5, v6
    s_lshl_b32 s12, s33, 10
    v_mov_b32 v62, 0
    s_lshl_b32 s40, s33, 3
    s_add_u32 s40, s40, s49
    s_mul_i32 s50, s40, 896
    s_lshr_b32 s40, s33, 1
    s_lshl_b32 s40, s40, 2
    v_or_b32 v10, s40, v2
    v_lshlrev_b32 v10, 1, v10
    v_xor_b32 v10, v10, v1
    v_lshlrev_b32 v10, 4, v10
    s_lshl_b32 s40, s33, 2
    v_add_u32 v11, s40, v2
    v_mul_u32_u24 v6, 3584, v11
    s_lshl_b32 s40, s48, 8
    v_add3_u32 v6, v6, v10, s40
    v_add_u32 v7, 57344, v6
    s_lshl_b32 s51, s15, 7
    s_mul_i32 s52, s15, 229376
    s_waitcnt lgkmcnt(0)
    s_mov_b32 s16, s4
    s_mov_b32 s17, s5
    s_mov_b32 s18, 1835008
    s_mov_b32 s19, 0x00020000
    s_mov_b32 s20, s8
    s_mov_b32 s21, s9
    s_mov_b32 s22, 1605632
    s_mov_b32 s23, 0x00020000
    s_mov_b32 s24, s10
    s_mov_b32 s25, s11
    s_mov_b32 s26, 1605632
    s_mov_b32 s27, 0x00020000
    s_add_u32 s53, s51, s50
    s_add_u32 s51, s51, 128
    s_cmp_ge_u32 s51, 896
    s_cselect_b32 s51, 0, s51
    s_cmp_ge_u32 s33, 2
    s_cbranch_scc1 G_XSKIP0
    s_add_u32 m0, s12, 20480
    s_add_u32 s43, s53, 143360
    buffer_load_dwordx4 v5, s[16:19], s43 offen lds
G_XSKIP0:
    s_add_u32 m0, s12, 0
    s_add_u32 s43, s53, 0
    buffer_load_dwordx4 v5, s[16:19], s43 offen lds
    s_add_u32 m0, s12, 4096
    s_add_u32 s43, s53, 28672
    buffer_load_dwordx4 v5, s[16:19], s43 offen lds
    s_add_u32 m0, s12, 8192
    s_add_u32 s43, s53, 57344
    buffer_load_dwordx4 v5, s[16:19], s43 offen lds
    s_add_u32 m0, s12, 12288
    s_add_u32 s43, s53, 86016
    buffer_load_dwordx4 v5, s[16:19], s43 offen lds
    s_add_u32 m0, s12, 16384
    s_add_u32 s43, s53, 114688
    buffer_load_dwordx4 v5, s[16:19], s43 offen lds
    s_add_u32 m0, s12, 67584
    s_nop 0
    buffer_load_dwordx4 v6, s[20:23], s52 offen lds
    s_add_u32 m0, s12, 71680
    s_nop 0
    buffer_load_dwordx4 v7, s[20:23], s52 offen lds
    s_add_u32 m0, s12, 75776
    s_nop 0
    buffer_load_dwordx4 v6, s[24:27], s52 offen lds
    s_add_u32 m0, s12, 79872
    s_nop 0
    buffer_load_dwordx4 v7, s[24:27], s52 offen lds
    s_add_u32 s52, s52, 114688
    s_add_u32 m0, s12, 83968
    s_nop 0
    buffer_load_dwordx4 v6, s[20:23], s52 offen lds
    s_add_u32 m0, s12, 88064
    s_nop 0
    buffer_load_dwordx4 v7, s[20:23], s52 offen lds
    s_add_u32 m0, s12, 92160
    s_nop 0
    buffer_load_dwordx4 v6, s[24:27], s52 offen lds
    s_add_u32 m0, s12, 96256
    s_nop 0
    buffer_load_dwordx4 v7, s[24:27], s52 offen lds
    s_add_u32 s52, s52, 114688
    s_cmp_ge_u32 s52, 1605632
    s_cselect_b32 s52, 0, s52
    s_add_u32 m0, s12, 100352
    s_nop 0
    buffer_load_dwordx4 v6, s[20:23], s52 offen lds
    s_add_u32 m0, s12, 104448
    s_nop 0
    buffer_load_dwordx4 v7, s[20:23], s52 offen lds
    s_add_u32 m0, s12, 108544
    s_nop 0
    buffer_load_dwordx4 v6, s[24:27], s52 offen lds
    s_add_u32 m0, s12, 112640
    s_nop 0
    buffer_load_dwordx4 v7, s[24:27], s52 offen lds
    s_add_u32 s52, s52, 114688
    s_branch GH_CONT
K_QKV:
    s_mov_b32 s48, s3
    s_sub_u32 s50, s2, 21
    s_mul_i32 s49, s50, 190
    s_lshl_b32 s38, s50, 5
    s_add_u32 s38, s38, s48
    s_lshl_b32 s38, s38, 2
    s_add_u32 s38, s38, 1536
    s_mov_b32 s13, 1
    s_cmp_lt_u32 s14, 4
    s_cbranch_scc1 Q_COMPUTE
    v_lshrrev_b32 v3, 3, v0
    v_and_b32 v4, 7, v0
    s_and_b32 s40, s33, 1
    s_lshl_b32 s40, s40, 2
    v_add_u32 v6, s40, v2
    v_xor_b32 v6, v6, v4
    v_lshlrev_b32 v6, 4, v6
    v_mul_u32_u24 v5, 896, v3
    v_add_u32 v5, v5, v6
    s_lshl_b32 s12, s33, 10
    v_mov_b32 v62, 0
    s_mov_b32 s34, 0x80008000
    s_mov_b32 s35, 0x80008000
    s_lshl_b32 s40, s33, 3
    s_add_u32 s40, s40, s49
    s_sub_i32 s40, s40, 16
    s_mul_i32 s52, s40, 896
    s_cmp_lt_i32 s40, 0
    s_cselect_b32 s51, 1073741824, s52
    s_lshr_b32 s41, s33, 1
    s_mul_i32 s41, s41, 896
    s_sub_u32 s53, s52, s41
    s_add_u32 s53, s53, 86016
    v_and_b32 v10, 1, v2
    s_and_b32 s40, s33, 1
    s_lshl_b32 s40, s40, 1
    v_or_b32 v10, s40, v10
    v_lshlrev_b32 v10, 1, v10
    v_xor_b32 v10, v10, v4
    s_lshl_b32 s40, s33, 3
    v_add_u32 v11, s40, v3
    v_mul_u32_u24 v11, 2688, v11
    s_mul_i32 s40, s48, 112
    v_lshl_add_u32 v11, v10, 4, v11
    v_add_u32 v11, s40, v11
    v_cmp_eq_u32 vcc, 7, v10
    v_mov_b32 v12, 1073741824
    s_lshl_b32 s54, s15, 7
    s_mul_i32 s55, s15, 172032
    v_cndmask_b32 v6, v11, v12, vcc
    s_waitcnt lgkmcnt(0)
    s_mov_b32 s16, s4
    s_mov_b32 s17, s5
    s_mov_b32 s18, 1835008
    s_mov_b32 s19, 0x00020000
    s_mov_b32 s20, s6
    s_mov_b32 s21, s7
    s_mov_b32 s22, 1204224
    s_mov_b32 s23, 0x00020000
    s_add_u32 s24, s54, s52
    s_cmp_ge_u32 s33, 2
    s_cbranch_scc1 Q_XSKIP0
    s_add_u32 m0, s12, 24576
    s_add_u32 s43, s24, 171136
    buffer_load_dwordx4 v5, s[16:19], s43 offen lds
Q_XSKIP0:
    s_add_u32 m0, s12, 0
    s_add_u32 s43, s54, s51
    buffer_load_dwordx4 v5, s[16:19], s43 offen lds
    s_add_u32 m0, s12, 4096
    s_add_u32 s43, s24, 28672
    buffer_load_dwordx4 v5, s[16:19], s43 offen lds
    s_add_u32 m0, s12, 8192
    s_add_u32 s43, s24, 57344
    buffer_load_dwordx4 v5, s[16:19], s43 offen lds
    s_add_u32 m0, s12, 12288
    s_add_u32 s43, s54, s53
    buffer_load_dwordx4 v5, s[16:19], s43 offen lds
    s_add_u32 m0, s12, 16384
    s_add_u32 s43, s24, 113792
    buffer_load_dwordx4 v5, s[16:19], s43 offen lds
    s_add_u32 m0, s12, 20480
    s_add_u32 s43, s24, 142464
    buffer_load_dwordx4 v5, s[16:19], s43 offen lds
    s_add_u32 s54, s54, 128
    s_cmp_ge_u32 s54, 896
    s_cselect_b32 s54, 0, s54
    s_add_u32 m0, s12, 79872
    s_add_u32 s43, s55, 0
    buffer_load_dwordx4 v6, s[20:23], s43 offen lds
    s_add_u32 m0, s12, 83968
    s_add_u32 s43, s55, 896
    buffer_load_dwordx4 v6, s[20:23], s43 offen lds
    s_add_u32 m0, s12, 88064
    s_add_u32 s43, s55, 1792
    buffer_load_dwordx4 v6, s[20:23], s43 offen lds
    s_add_u32 s55, s55, 86016
    s_add_u32 m0, s12, 92160
    s_add_u32 s43, s55, 0
    buffer_load_dwordx4 v6, s[20:23], s43 offen lds
    s_add_u32 m0, s12, 96256
    s_add_u32 s43, s55, 896
    buffer_load_dwordx4 v6, s[20:23], s43 offen lds
    s_add_u32 m0, s12, 100352
    s_add_u32 s43, s55, 1792
    buffer_load_dwordx4 v6, s[20:23], s43 offen lds
    s_add_u32 s55, s55, 86016
    s_cmp_ge_u32 s55, 1204224
    s_cselect_b32 s55, 0, s55
    s_add_u32 m0, s12, 104448
    s_add_u32 s43, s55, 0
    buffer_load_dwordx4 v6, s[20:23], s43 offen lds
    s_add_u32 m0, s12, 108544
    s_add_u32 s43, s55, 896
    buffer_load_dwordx4 v6, s[20:23], s43 offen lds
    s_add_u32 m0, s12, 112640
    s_add_u32 s43, s55, 1792
    buffer_load_dwordx4 v6, s[20:23], s43 offen lds
    s_add_u32 s55, s55, 86016
    s_branch QH_CONT
GH_CONT:
    s_waitcnt vmcnt(8)
    s_barrier
    s_add_u32 s53, s51, s50
    s_add_u32 s51, s51, 128
    s_cmp_ge_u32 s51, 896
    s_cselect_b32 s51, 0, s51
    s_cmp_ge_u32 s33, 2
    s_cbranch_scc1 G_XSKIP1
    s_add_u32 m0, s12, 43008
    s_add_u32 s43, s53, 143360
    buffer_load_dwordx4 v5, s[16:19], s43 offen lds
G_XSKIP1:
    s_add_u32 m0, s12, 22528
    s_add_u32 s43, s53, 0
    buffer_load_dwordx4 v5, s[16:19], s43 offen lds
    s_add_u32 m0, s12, 26624
    s_add_u32 s43, s53, 28672
    buffer_load_dwordx4 v5, s[16:19], s43 offen lds
    s_add_u32 m0, s12, 30720
    s_add_u32 s43, s53, 57344
    buffer_load_dwordx4 v5, s[16:19], s43 offen lds
    s_add_u32 m0, s12, 34816
    s_add_u32 s43, s53, 86016
    buffer_load_dwordx4 v5, s[16:19], s43 offen lds
    s_add_u32 m0, s12, 38912
    s_add_u32 s43, s53, 114688
    buffer_load_dwordx4 v5, s[16:19], s43 offen lds
    s_waitcnt vmcnt(9)
    s_barrier
    s_add_u32 m0, s12, 116736
    s_nop 0
    buffer_load_dwordx4 v6, s[20:23], s52 offen lds
    s_add_u32 m0, s12, 120832
    s_nop 0
    buffer_load_dwordx4 v7, s[20:23], s52 offen lds
    s_add_u32 m0, s12, 124928
    s_nop 0
    buffer_load_dwordx4 v6, s[24:27], s52 offen lds
    s_add_u32 m0, s12, 129024
    s_nop 0
    buffer_load_dwordx4 v7, s[24:27], s52 offen lds
    s_add_u32 s52, s52, 114688
    s_cmp_ge_u32 s52, 1605632
    s_cselect_b32 s52, 0, s52
    s_add_u32 s53, s51, s50
    s_add_u32 s51, s51, 128
    s_cmp_ge_u32 s51, 896
    s_cselect_b32 s51, 0, s51
    s_cmp_ge_u32 s33, 2
    s_cbranch_scc1 G_XSKIP2
    s_add_u32 m0, s12, 65536
    s_add_u32 s43, s53, 143360
    buffer_load_dwordx4 v5, s[16:19], s43 offen lds
G_XSKIP2:
    s_add_u32 m0, s12, 45056
    s_add_u32 s43, s53, 0
    buffer_load_dwordx4 v5, s[16:19], s43 offen lds
    s_add_u32 m0, s12, 49152
    s_add_u32 s43, s53, 28672
    buffer_load_dwordx4 v5, s[16:19], s43 offen lds
    s_add_u32 m0, s12, 53248
    s_add_u32 s43, s53, 57344
    buffer_load_dwordx4 v5, s[16:19], s43 offen lds
    s_lshl_b32 s40, s55, 2
    s_add_u32 s40, s40, s33
    s_cmp_lt_u32 s40, 24
    s_cselect_b32 s28, s8, s10
    s_cselect_b32 s29, s9, s11
    s_cselect_b32 s41, 0, 24
    s_mov_b32 s30, 1605632
    s_mov_b32 s31, 0x00020000
    s_sub_u32 s40, s40, s41
    s_mul_i32 s40, s40, 68096
    s_lshl_b32 s41, s48, 8
    s_add_u32 s40, s40, s41
    v_min_u32 v10, 37, v0
    v_and_b32 v11, 1, v10
    v_lshrrev_b32 v10, 1, v10
    v_mul_u32_u24 v10, 3584, v10
    s_mov_b32 m0, 157712
    v_lshl_add_u32 v10, v11, 7, v10
    buffer_load_dword v10, s[28:31], s40 offen lds
    s_lshl_b32 s40, s2, 3
    s_add_u32 s40, s40, s3
    s_cmp_lt_u32 s40, 196
    s_cselect_b32 s28, s68, s76
    s_cselect_b32 s29, s69, s77
    s_mov_b32 s41, 401408
    s_cselect_b32 s30, 1605632, s41
    s_cselect_b32 s41, 0, 196
    s_mov_b32 s31, 0x00020000
    s_sub_u32 s41, s40, s41
    s_lshl_b32 s41, s41, 13
    s_lshl_b32 s40, s33, 11
    s_add_u32 s41, s41, s40
    s_mov_b32 m0, 157712
    v_lshlrev_b32 v10, 7, v1
    buffer_load_dword v10, s[28:31], s41 offen lds
    s_add_u32 s64, s74, 9764864
    s_addc_u32 s65, s75, 0
    s_mov_b32 s66, 3072
    s_mov_b32 s67, 0x00020000
    s_add_u32 s28, s74, 9732096
    s_addc_u32 s29, s75, 0
    s_mov_b32 s30, 32768
    s_mov_b32 s31, 0x00020000
    s_lshl_b32 s40, s33, 6
    v_add_u32 v10, s40, v0
    v_cmp_gt_u32 vcc, 175, v10
    v_lshlrev_b32 v8, 2, v10
    v_add_u32 v8, 149504, v8
    v_add_u32 v10, s49, v10
    v_lshlrev_b32 v10, 4, v10
    v_mov_b32 v11, 1073741824
    v_cndmask_b32 v9, v11, v10, vcc
    v_and_b32 v10, 1, v2
    v_lshlrev_b32 v10, 2, v10
    v_and_b32 v11, 2, v2
    v_or_b32 v10, v10, v11
    v_xor_b32 v10, v10, v4
    s_lshl_b32 s41, s33, 3
    v_add_u32 v11, s41, v3
    v_mul_u32_u24 v60, 896, v11
    v_lshl_add_u32 v60, v10, 4, v60
    s_lshl_b32 s41, s79, 7
    v_add_u32 v60, s41, v60
    v_cmp_le_u32 vcc, 28, v11
    v_mov_b32 v10, 1073741824
    s_cmp_lt_u32 s79, 7
    s_mov_b32 s56, s68
    s_mov_b32 s57, s69
    s_cselect_b32 s58, 1605632, 0
    s_mov_b32 s59, 0x00020000
    s_mov_b32 s60, s76
    s_mov_b32 s61, s77
    s_cselect_b32 s62, 401408, 0
    s_mov_b32 s63, 0x00020000
    v_cndmask_b32 v61, v60, v10, vcc
    s_waitcnt vmcnt(9)
    s_barrier
    s_add_u32 m0, s12, 57344
    s_add_u32 s43, s53, 86016
    buffer_load_dwordx4 v5, s[16:19], s43 offen lds
    s_add_u32 m0, s12, 61440
    s_add_u32 s43, s53, 114688
    buffer_load_dwordx4 v5, s[16:19], s43 offen lds
    s_add_u32 m0, s12, 133120
    s_nop 0
    buffer_load_dwordx4 v6, s[20:23], s52 offen lds
    s_add_u32 m0, s12, 137216
    s_nop 0
    buffer_load_dwordx4 v7, s[20:23], s52 offen lds
    s_add_u32 m0, s12, 141312
    s_nop 0
    buffer_load_dwordx4 v6, s[24:27], s52 offen lds
    s_add_u32 m0, s12, 145408
    s_nop 0
    buffer_load_dwordx4 v7, s[24:27], s52 offen lds
    s_add_u32 s52, s52, 114688
    s_add_u32 m0, s12, 67584
    s_nop 0
    buffer_load_dwordx4 v6, s[20:23], s52 offen lds
    s_add_u32 m0, s12, 71680
    s_nop 0
    buffer_load_dwordx4 v7, s[20:23], s52 offen lds
    s_waitcnt vmcnt(13)
    s_barrier
    s_add_u32 m0, s12, 75776
    s_nop 0
    buffer_load_dwordx4 v6, s[24:27], s52 offen lds
    s_add_u32 m0, s12, 79872
    s_nop 0
    buffer_load_dwordx4 v7, s[24:27], s52 offen lds
    s_add_u32 s52, s52, 114688
    s_cmp_ge_u32 s52, 1605632
    s_cselect_b32 s52, 0, s52
    s_add_u32 s53, s51, s50
    s_add_u32 s51, s51, 128
    s_cmp_ge_u32 s51, 896
    s_cselect_b32 s51, 0, s51
    s_cmp_ge_u32 s33, 2
    s_cbranch_scc1 G_XSKIP3
    s_add_u32 m0, s12, 20480
    s_add_u32 s43, s53, 143360
    buffer_load_dwordx4 v5, s[16:19], s43 offen lds
G_XSKIP3:
    s_add_u32 m0, s12, 0
    s_add_u32 s43, s53, 0
    buffer_load_dwordx4 v5, s[16:19], s43 offen lds
    s_add_u32 m0, s12, 4096
    s_add_u32 s43, s53, 28672
    buffer_load_dwordx4 v5, s[16:19], s43 offen lds
    s_add_u32 m0, s12, 8192
    s_add_u32 s43, s53, 57344
    buffer_load_dwordx4 v5, s[16:19], s43 offen lds
    s_add_u32 m0, s12, 12288
    s_add_u32 s43, s53, 86016
    buffer_load_dwordx4 v5, s[16:19], s43 offen lds
    s_add_u32 m0, s12, 16384
    s_add_u32 s43, s53, 114688
    buffer_load_dwordx4 v5, s[16:19], s43 offen lds
    s_waitcnt vmcnt(9)
    s_barrier
    s_add_u32 m0, s12, 83968
    s_nop 0
    buffer_load_dwordx4 v6, s[20:23], s52 offen lds
    s_add_u32 m0, s12, 88064
    s_nop 0
    buffer_load_dwordx4 v7, s[20:23], s52 offen lds
    s_add_u32 m0, s12, 92160
    s_nop 0
    buffer_load_dwordx4 v6, s[24:27], s52 offen lds
    s_add_u32 m0, s12, 96256
    s_nop 0
    buffer_load_dwordx4 v7, s[24:27], s52 offen lds
    s_add_u32 s52, s52, 114688
    s_add_u32 m0, s12, 100352
    s_nop 0
    buffer_load_dwordx4 v6, s[20:23], s52 offen lds
    s_add_u32 m0, s12, 104448
    s_nop 0
    buffer_load_dwordx4 v7, s[20:23], s52 offen lds
    s_add_u32 m0, s12, 108544
    s_nop 0
    buffer_load_dwordx4 v6, s[24:27], s52 offen lds
    s_add_u32 m0, s12, 112640
    s_nop 0
    buffer_load_dwordx4 v7, s[24:27], s52 offen lds
    s_add_u32 s52, s52, 114688
    s_cmp_ge_u32 s52, 1605632
    s_cselect_b32 s52, 0, s52
    s_load_dword s39, s[72:73], 0
    s_waitcnt vmcnt(13)
    s_barrier
    s_add_u32 s53, s51, s50
    s_add_u32 s51, s51, 128
    s_cmp_ge_u32 s51, 896
    s_cselect_b32 s51, 0, s51
    s_cmp_ge_u32 s33, 2
    s_cbranch_scc1 G_XSKIP4
    s_add_u32 m0, s12, 43008
    s_add_u32 s43, s53, 143360
    buffer_load_dwordx4 v5, s[16:19], s43 offen lds
G_XSKIP4:
    s_add_u32 m0, s12, 22528
    s_add_u32 s43, s53, 0
    buffer_load_dwordx4 v5, s[16:19], s43 offen lds
    s_add_u32 m0, s12, 26624
    s_add_u32 s43, s53, 28672
    buffer_load_dwordx4 v5, s[16:19], s43 offen lds
    s_add_u32 m0, s12, 30720
    s_add_u32 s43, s53, 57344
    buffer_load_dwordx4 v5, s[16:19], s43 offen lds
    s_add_u32 m0, s12, 34816
    s_add_u32 s43, s53, 86016
    buffer_load_dwordx4 v5, s[16:19], s43 offen lds
    s_add_u32 m0, s12, 38912
    s_add_u32 s43, s53, 114688
    buffer_load_dwordx4 v5, s[16:19], s43 offen lds
    s_add_u32 m0, s12, 116736
    s_nop 0
    buffer_load_dwordx4 v6, s[20:23], s52 offen lds
    s_add_u32 m0, s12, 120832
    s_nop 0
    buffer_load_dwordx4 v7, s[20:23], s52 offen lds
    v_lshlrev_b32 v24, 2, v0
    v_add_u32 v24, 157968, v24
    ds_read_b32 v20, v24
    s_waitcnt lgkmcnt(0)
    v_mov_b32 v63, s39
    s_cmp_lg_u32 s39, 0
    s_cbranch_scc1 G_SP_HAVE
    s_mov_b32 s44, 0
G_SP_T_LOOP:
    global_load_dword v63, v62, s[72:73] sc1
G_SP_T_CHK:
    s_add_u32 s44, s44, 1
    s_waitcnt vmcnt(0)
    v_readfirstlane_b32 s45, v63
    s_cmp_ge_u32 s44, 60000
    s_cbranch_scc1 G_SP_T_DONE
    s_nop 1
    s_cmp_eq_u32 s45, 0
    s_cbranch_scc1 G_SP_T_LOOP
G_SP_T_DONE:
G_SP_HAVE:
    s_cmp_lg_u32 s33, 0
    s_cbranch_scc1 G_SP_SKIP
    s_lshl_b32 s40, s2, 3
    s_add_u32 s40, s40, s3
    s_lshl_b32 s40, s40, 7
    v_mov_b32 v21, v63
    v_mov_b32 v23, v63
    v_lshlrev_b32 v24, 4, v0
    v_mov_b32 v22, v20
    s_mov_b64 exec, 0xff
    buffer_store_dwordx4 v[20:23], v24, s[28:31], s40 offen sc1
    s_mov_b64 exec, -1
G_SP_SKIP:
    s_waitcnt vmcnt(11)
    s_barrier
    s_add_u32 m0, s12, 124928
    s_nop 0
    buffer_load_dwordx4 v6, s[24:27], s52 offen lds
    s_add_u32 m0, s12, 129024
    s_nop 0
    buffer_load_dwordx4 v7, s[24:27], s52 offen lds
    s_add_u32 s52, s52, 114688
    s_add_u32 m0, s12, 133120
    s_nop 0
    buffer_load_dwordx4 v6, s[20:23], s52 offen lds
    s_add_u32 m0, s12, 137216
    s_nop 0
    buffer_load_dwordx4 v7, s[20:23], s52 offen lds
    s_add_u32 m0, s12, 141312
    s_nop 0
    buffer_load_dwordx4 v6, s[24:27], s52 offen lds
    s_add_u32 m0, s12, 145408
    s_nop 0
    buffer_load_dwordx4 v7, s[24:27], s52 offen lds
    s_add_u32 s52, s52, 114688
    s_cmp_ge_u32 s52, 1605632
    s_cselect_b32 s52, 0, s52
    s_add_u32 m0, s12, 67584
    s_nop 0
    buffer_load_dwordx4 v6, s[20:23], s52 offen lds
    s_add_u32 m0, s12, 71680
    s_nop 0
    buffer_load_dwordx4 v7, s[20:23], s52 offen lds
    s_waitcnt vmcnt(15)
    s_barrier
    s_add_u32 s53, s51, s50
    s_add_u32 s51, s51, 128
    s_cmp_ge_u32 s51, 896
    s_cselect_b32 s51, 0, s51
    s_cmp_ge_u32 s33, 2
    s_cbranch_scc1 G_XSKIP5
    s_add_u32 m0, s12, 65536
    s_add_u32 s43, s53, 143360
    buffer_load_dwordx4 v5, s[16:19], s43 offen lds
G_XSKIP5:
    s_add_u32 m0, s12, 45056
    s_add_u32 s43, s53, 0
    buffer_load_dwordx4 v5, s[16:19], s43 offen lds
    s_add_u32 m0, s12, 49152
    s_add_u32 s43, s53, 28672
    buffer_load_dwordx4 v5, s[16:19], s43 offen lds
    s_add_u32 m0, s12, 53248
    s_add_u32 s43, s53, 57344
    buffer_load_dwordx4 v5, s[16:19], s43 offen lds
    s_add_u32 m0, s12, 57344
    s_add_u32 s43, s53, 86016
    buffer_load_dwordx4 v5, s[16:19], s43 offen lds
    s_add_u32 m0, s12, 61440
    s_add_u32 s43, s53, 114688
    buffer_load_dwordx4 v5, s[16:19], s43 offen lds
    s_add_u32 m0, s12, 75776
    s_nop 0
    buffer_load_dwordx4 v6, s[24:27], s52 offen lds
    s_add_u32 m0, s12, 79872
    s_nop 0
    buffer_load_dwordx4 v7, s[24:27], s52 offen lds
    s_add_u32 s52, s52, 114688
    s_waitcnt vmcnt(13)
    s_barrier
    s_add_u32 m0, s12, 83968
    s_nop 0
    buffer_load_dwordx4 v6, s[20:23], s52 offen lds
    s_add_u32 m0, s12, 88064
    s_nop 0
    buffer_load_dwordx4 v7, s[20:23], s52 offen lds
    s_add_u32 m0, s12, 92160
    s_nop 0
    buffer_load_dwordx4 v6, s[24:27], s52 offen lds
    s_add_u32 m0, s12, 96256
    s_nop 0
    buffer_load_dwordx4 v7, s[24:27], s52 offen lds
    s_add_u32 s52, s52, 114688
    s_cmp_ge_u32 s52, 1605632
    s_cselect_b32 s52, 0, s52
    s_add_u32 m0, s12, 100352
    s_nop 0
    buffer_load_dwordx4 v6, s[20:23], s52 offen lds
    s_add_u32 m0, s12, 104448
    s_nop 0
    buffer_load_dwordx4 v7, s[20:23], s52 offen lds
    s_add_u32 m0, s12, 108544
    s_nop 0
    buffer_load_dwordx4 v6, s[24:27], s52 offen lds
    s_add_u32 m0, s12, 112640
    s_nop 0
    buffer_load_dwordx4 v7, s[24:27], s52 offen lds
    s_add_u32 s52, s52, 114688
    s_waitcnt vmcnt(17)
    s_barrier
    s_add_u32 s53, s51, s50
    s_add_u32 s51, s51, 128
    s_cmp_ge_u32 s51, 896
    s_cselect_b32 s51, 0, s51
    s_cmp_ge_u32 s33, 2
    s_cbranch_scc1 G_XSKIP6
    s_add_u32 m0, s12, 20480
    s_add_u32 s43, s53, 143360
    buffer_load_dwordx4 v5, s[16:19], s43 offen lds
G_XSKIP6:
    s_add_u32 m0, s12, 0
    s_add_u32 s43, s53, 0
    buffer_load_dwordx4 v5, s[16:19], s43 offen lds
    s_add_u32 m0, s12, 4096
    s_add_u32 s43, s53, 28672
    buffer_load_dwordx4 v5, s[16:19], s43 offen lds
    s_add_u32 m0, s12, 8192
    s_add_u32 s43, s53, 57344
    buffer_load_dwordx4 v5, s[16:19], s43 offen lds
    s_add_u32 m0, s12, 12288
    s_add_u32 s43, s53, 86016
    buffer_load_dwordx4 v5, s[16:19], s43 offen lds
    s_add_u32 m0, s12, 16384
    s_add_u32 s43, s53, 114688
    buffer_load_dwordx4 v5, s[16:19], s43 offen lds
    s_add_u32 m0, s12, 116736
    s_nop 0
    buffer_load_dwordx4 v6, s[20:23], s52 offen lds
    s_add_u32 m0, s12, 120832
    s_nop 0
    buffer_load_dwordx4 v7, s[20:23], s52 offen lds
    s_add_u32 m0, s12, 124928
    s_nop 0
    buffer_load_dwordx4 v6, s[24:27], s52 offen lds
    s_waitcnt vmcnt(16)
    s_barrier
    buffer_load_dwordx2 v[16:17], v9, s[28:31], 0 offen sc1
    s_add_u32 m0, s12, 129024
    s_nop 0
    buffer_load_dwordx4 v7, s[24:27], s52 offen lds
    s_add_u32 s52, s52, 114688
    s_cmp_ge_u32 s52, 1605632
    s_cselect_b32 s52, 0, s52
    s_add_u32 m0, s12, 139264
    s_mov_b32 s43, 602112
    buffer_load_dwordx4 v60, s[56:59], s43 offen lds
    s_add_u32 m0, s12, 143360
    s_mov_b32 s43, 659456
    buffer_load_dwordx4 v60, s[56:59], s43 offen lds
    s_mov_b32 s43, 688128
    buffer_load_dwordx4 v[64:67], v60, s[56:59], s43 offen
    s_mov_b32 s43, 745472
    buffer_load_dwordx4 v[68:71], v60, s[56:59], s43 offen
    s_mov_b32 s43, 716800
    buffer_load_dwordx4 v[72:75], v60, s[56:59], s43 offen
    s_mov_b32 s43, 774144
    buffer_load_dwordx4 v[76:79], v60, s[56:59], s43 offen
    s_mov_b32 s43, 802816
    buffer_load_dwordx4 v[80:83], v60, s[56:59], s43 offen
    s_mov_b32 s43, 860160
    buffer_load_dwordx4 v[84:87], v60, s[56:59], s43 offen
    s_mov_b32 s43, 831488
    buffer_load_dwordx4 v[88:91], v60, s[56:59], s43 offen
    s_waitcnt vmcnt(23)
    s_barrier
    s_add_u32 m0, s12, 73728
    s_mov_b32 s43, 143360
    buffer_load_dwordx4 v60, s[56:59], s43 offen lds
    s_add_u32 m0, s12, 77824
    s_mov_b32 s43, 200704
    buffer_load_dwordx4 v60, s[56:59], s43 offen lds
    s_mov_b32 s43, 888832
    buffer_load_dwordx4 v[92:95], v60, s[56:59], s43 offen
    s_mov_b32 s43, 917504
    buffer_load_dwordx4 v[96:99], v60, s[56:59], s43 offen
    s_mov_b32 s43, 974848
    buffer_load_dwordx4 v[100:103], v60, s[56:59], s43 offen
    s_mov_b32 s43, 946176
    buffer_load_dwordx4 v[104:107], v60, s[56:59], s43 offen
    s_mov_b32 s43, 1003520
    buffer_load_dwordx4 v[108:111], v60, s[56:59], s43 offen
    s_mov_b32 s43, 1032192
    buffer_load_dwordx4 v[112:115], v60, s[56:59], s43 offen
    s_mov_b32 s43, 1089536
    buffer_load_dwordx4 v[116:119], v60, s[56:59], s43 offen
    s_mov_b32 s43, 1060864
    buffer_load_dwordx4 v[120:123], v60, s[56:59], s43 offen
    s_waitcnt vmcnt(24)
    s_barrier
    s_mov_b32 s44, 32768
    v_cmp_gt_u32 s[40:41], s44, v9
    s_mov_b32 s44, 0
    s_waitcnt vmcnt(20)
G_SC_CHK:
    v_cmp_eq_u32 vcc, v63, v17
    s_add_u32 s44, s44, 1
    s_cmp_ge_u32 s44, 60000
    s_cbranch_scc1 G_SC_OK
    s_andn2_b64 s[42:43], s[40:41], vcc
    s_cbranch_scc0 G_SC_OK
    buffer_load_dwordx2 v[16:17], v9, s[28:31], 0 offen sc1
    s_waitcnt vmcnt(0)
    s_branch G_SC_CHK
G_SC_OK:
    v_lshlrev_b32 v16, 16, v16
    ds_write_b32 v8, v16
    s_waitcnt lgkmcnt(0)
    s_add_u32 m0, s12, 81920
    s_mov_b32 s43, 229376
    buffer_load_dwordx4 v60, s[56:59], s43 offen lds
    s_add_u32 m0, s12, 86016
    s_mov_b32 s43, 286720
    buffer_load_dwordx4 v60, s[56:59], s43 offen lds
    s_add_u32 m0, s12, 90112
    s_mov_b32 s43, 258048
    buffer_load_dwordx4 v60, s[56:59], s43 offen lds
    s_add_u32 m0, s12, 94208
    s_mov_b32 s43, 315392
    buffer_load_dwordx4 v60, s[56:59], s43 offen lds
    s_mov_b32 s43, 1118208
    buffer_load_dwordx4 v[124:127], v60, s[56:59], s43 offen
    s_mov_b32 s43, 1146880
    buffer_load_dwordx4 v[128:131], v60, s[56:59], s43 offen
    s_mov_b32 s43, 1204224
    buffer_load_dwordx4 v[132:135], v60, s[56:59], s43 offen
    s_mov_b32 s43, 1175552
    buffer_load_dwordx4 v[136:139], v60, s[56:59], s43 offen
    s_mov_b32 s43, 1232896
    buffer_load_dwordx4 v[140:143], v60, s[56:59], s43 offen
    s_mov_b32 s43, 1261568
    buffer_load_dwordx4 v[144:147], v60, s[56:59], s43 offen
    s_waitcnt vmcnt(29)
    s_barrier
    s_add_u32 m0, s12, 49152
    s_mov_b32 s43, 0
    buffer_load_dwordx4 v60, s[56:59], s43 offen lds
    s_add_u32 m0, s12, 53248
    s_mov_b32 s43, 57344
    buffer_load_dwordx4 v60, s[56:59], s43 offen lds
    s_add_u32 m0, s12, 57344
    s_mov_b32 s43, 28672
    buffer_load_dwordx4 v60, s[56:59], s43 offen lds
    s_add_u32 m0, s12, 61440
    s_mov_b32 s43, 86016
    buffer_load_dwordx4 v60, s[56:59], s43 offen lds
    s_waitcnt lgkmcnt(0)
    s_barrier
    s_add_u32 m0, s12, 65536
    s_mov_b32 s43, 114688
    buffer_load_dwordx4 v60, s[56:59], s43 offen lds
    s_add_u32 m0, s12, 69632
    s_mov_b32 s43, 172032
    buffer_load_dwordx4 v60, s[56:59], s43 offen lds
    s_add_u32 m0, s12, 98304
    s_mov_b32 s43, 344064
    buffer_load_dwordx4 v60, s[56:59], s43 offen lds
    s_add_u32 m0, s12, 102400
    s_mov_b32 s43, 401408
    buffer_load_dwordx4 v60, s[56:59], s43 offen lds
    s_add_u32 m0, s12, 106496
    s_mov_b32 s43, 372736
    buffer_load_dwordx4 v60, s[56:59], s43 offen lds
    s_add_u32 m0, s12, 110592
    s_mov_b32 s43, 430080
    buffer_load_dwordx4 v60, s[56:59], s43 offen lds
    s_add_u32 m0, s12, 114688
    s_mov_b32 s43, 458752
    buffer_load_dwordx4 v60, s[56:59], s43 offen lds
    s_add_u32 m0, s12, 118784
    s_mov_b32 s43, 516096
    buffer_load_dwordx4 v60, s[56:59], s43 offen lds
    s_add_u32 m0, s12, 122880
    s_mov_b32 s43, 487424
    buffer_load_dwordx4 v60, s[56:59], s43 offen lds
    s_add_u32 m0, s12, 126976
    s_mov_b32 s43, 544768
    buffer_load_dwordx4 v60, s[56:59], s43 offen lds
    s_add_u32 m0, s12, 131072
    s_mov_b32 s43, 573440
    buffer_load_dwordx4 v60, s[56:59], s43 offen lds
    s_add_u32 m0, s12, 135168
    s_mov_b32 s43, 630784
    buffer_load_dwordx4 v60, s[56:59], s43 offen lds
    s_mov_b32 s43, 1318912
    buffer_load_dwordx4 v[148:151], v60, s[56:59], s43 offen
    s_mov_b32 s43, 1290240
    buffer_load_dwordx4 v[152:155], v60, s[56:59], s43 offen
    s_mov_b32 s43, 1347584
    buffer_load_dwordx4 v[156:159], v60, s[56:59], s43 offen
    s_mov_b32 s43, 1376256
    buffer_load_dwordx4 v[160:163], v60, s[56:59], s43 offen
    s_mov_b32 s43, 1433600
    buffer_load_dwordx4 v[164:167], v60, s[56:59], s43 offen
    s_mov_b32 s43, 1404928
    buffer_load_dwordx4 v[168:171], v60, s[56:59], s43 offen
    s_mov_b32 s43, 1462272
    buffer_load_dwordx4 v[172:175], v60, s[56:59], s43 offen
    s_mov_b32 s43, 1490944
    buffer_load_dwordx4 v[176:179], v60, s[56:59], s43 offen
    s_mov_b32 s43, 1548288
    buffer_load_dwordx4 v[180:183], v60, s[56:59], s43 offen
    s_mov_b32 s43, 1519616
    buffer_load_dwordx4 v[184:187], v60, s[56:59], s43 offen
    s_mov_b32 s43, 1576960
    buffer_load_dwordx4 v[188:191], v60, s[56:59], s43 offen
    s_lshl_b32 s40, s78, 6
    s_lshl_b32 s41, s33, 4
    s_add_u32 s40, s40, s41
    s_lshl_b32 s42, s79, 7
    v_lshl_add_u32 v31, v4, 4, s42
    v_add_u32 v28, s40, v3
    v_mul_u32_u24 v29, 745, v28
    v_lshrrev_b32 v29, 17, v29
    v_mul_u32_u24 v30, 176, v29
    v_sub_u32 v30, v28, v30
    v_sub_u32 v28, v28, v29
    v_cmp_eq_u32 vcc, 175, v30
    v_mov_b32 v30, 4096
    s_add_u32 s40, s40, 8
    v_cndmask_b32 v28, v28, v30, vcc
    v_lshlrev_b32 v10, 4, v28
    v_mul_u32_u24 v28, 896, v28
    v_add_u32 v8, v28, v31
    v_add_u32 v28, s40, v3
    v_mul_u32_u24 v29, 745, v28
    v_lshrrev_b32 v29, 17, v29
    v_mul_u32_u24 v30, 176, v29
    v_sub_u32 v30, v28, v30
    v_sub_u32 v28, v28, v29
    v_cmp_eq_u32 vcc, 175, v30
    v_mov_b32 v30, 4096
    s_add_u32 s40, s40, 8
    v_cndmask_b32 v28, v28, v30, vcc
    v_lshlrev_b32 v11, 4, v28
    v_mul_u32_u24 v28, 896, v28
    v_add_u32 v9, v28, v31
    v_lshl_add_u32 v12, v0, 4, s12
    s_lshr_b32 s41, s33, 1
    s_mul_i32 s41, s41, 16896
    s_and_b32 s42, s33, 1
    s_lshl_b32 s42, s42, 8
    s_add_u32 s41, s41, s42
    s_add_u32 s41, s41, 16384
    v_mul_u32_u24 v28, 1056, v4
    v_lshl_add_u32 v28, v3, 4, v28
    v_add_u32 v13, s41, v28
    s_mov_b32 s20, s70
    s_mov_b32 s21, s71
    s_mov_b32 s22, 1835008
    s_mov_b32 s23, 0x00020000
    s_barrier
    s_waitcnt vmcnt(0)
    s_barrier
    v_add_u32 v14, 147456, v12
    ds_write_b128 v14, v[64:67] offset:0
    ds_write_b128 v14, v[68:71] offset:4096
    s_mov_b32 s43, 0
    buffer_load_dwordx4 v[192:195], v61, s[60:63], s43 offen
    ds_write_b128 v14, v[72:75] offset:8192
    ds_write_b128 v14, v[76:79] offset:12288
    s_mov_b32 s43, 200704
    buffer_load_dwordx4 v[196:199], v61, s[60:63], s43 offen
    v_add_u32 v14, 0, v12
    ds_write_b128 v14, v[80:83] offset:0
    ds_write_b128 v14, v[84:87] offset:4096
    s_mov_b32 s43, 25088
    buffer_load_dwordx4 v[200:203], v61, s[60:63], s43 offen
    ds_write_b128 v14, v[88:91] offset:8192
    ds_write_b128 v14, v[92:95] offset:12288
    s_mov_b32 s43, 225792
    buffer_load_dwordx4 v[204:207], v61, s[60:63], s43 offen
    ds_write_b128 v14, v[96:99] offset:16384
    ds_write_b128 v14, v[100:103] offset:20480
    s_mov_b32 s43, 50176
    buffer_load_dwordx4 v[208:211], v61, s[60:63], s43 offen
    ds_write_b128 v14, v[104:107] offset:24576
    ds_write_b128 v14, v[108:111] offset:28672
    s_mov_b32 s43, 250880
    buffer_load_dwordx4 v[212:215], v61, s[60:63], s43 offen
    ds_write_b128 v14, v[112:115] offset:32768
    ds_write_b128 v14, v[116:119] offset:36864
    s_mov_b32 s43, 75264
    buffer_load_dwordx4 v[216:219], v61, s[60:63], s43 offen
    ds_write_b128 v14, v[120:123] offset:40960
    ds_write_b128 v14, v[124:127] offset:45056
    s_mov_b32 s43, 275968
    buffer_load_dwordx4 v[220:223], v61, s[60:63], s43 offen
    s_waitcnt lgkmcnt(0)
    s_barrier
    s_cmp_lt_u32 s3, 8
    s_cbranch_scc1 GH_EARLY
    s_barrier
GH_EARLY:
    v_add_u32 v14, 49152, v12
    ds_write_b128 v14, v[128:131] offset:0
    ds_write_b128 v14, v[132:135] offset:4096
    s_mov_b32 s43, 100352
    buffer_load_dwordx4 v[224:227], v61, s[60:63], s43 offen
    ds_write_b128 v14, v[136:139] offset:8192
    ds_write_b128 v14, v[140:143] offset:12288
    s_mov_b32 s43, 301056
    buffer_load_dwordx4 v[228:231], v61, s[60:63], s43 offen
    ds_write_b128 v14, v[144:147] offset:16384
    ds_write_b128 v14, v[148:151] offset:20480
    s_mov_b32 s43, 125440
    buffer_load_dwordx4 v[232:235], v61, s[60:63], s43 offen
    ds_write_b128 v14, v[152:155] offset:24576
    ds_write_b128 v14, v[156:159] offset:28672
    s_mov_b32 s43, 326144
    buffer_load_dwordx4 v[236:239], v61, s[60:63], s43 offen
    ds_write_b128 v14, v[160:163] offset:32768
    ds_write_b128 v14, v[164:167] offset:36864
    s_mov_b32 s43, 150528
    buffer_load_dwordx4 v[240:243], v61, s[60:63], s43 offen
    ds_write_b128 v14, v[168:171] offset:40960
    ds_write_b128 v14, v[172:175] offset:45056
    s_mov_b32 s43, 351232
    buffer_load_dwordx4 v[244:247], v61, s[60:63], s43 offen
    ds_write_b128 v14, v[176:179] offset:49152
    ds_write_b128 v14, v[180:183] offset:53248
    s_mov_b32 s43, 175616
    buffer_load_dwordx4 v[248:251], v61, s[60:63], s43 offen
    ds_write_b128 v14, v[184:187] offset:57344
    v_add_u32 v14, 110592, v12
    ds_write_b128 v14, v[188:191] offset:0
    s_mov_b32 s43, 376320
    buffer_load_dwordx4 v[252:255], v61, s[60:63], s43 offen
    s_waitcnt lgkmcnt(0)
    s_cmp_ge_u32 s3, 8
    s_cbranch_scc1 P2_HELPER
    s_barrier
    s_branch P2_HELPER
G_COMPUTE:
    s_mov_b32 s34, 0x80008000
    s_mov_b32 s35, 0x80008000
    s_setprio 2
    s_waitcnt lgkmcnt(0)
    v_mov_b32 v14, 0
    v_lshrrev_b32 v16, 1, v1
    v_xor_b32 v16, v16, v2
    v_lshlrev_b32 v16, 4, v16
    v_lshl_add_u32 v3, v1, 7, v16
    v_xor_b32 v4, 64, v3
    v_bfe_u32 v16, v0, 2, 2
    v_and_b32 v17, 1, v2
    v_lshl_or_b32 v17, v17, 2, v16
    s_lshl_b32 s40, s33, 1
    v_xor_b32 v17, s40, v17
    v_lshlrev_b32 v17, 5, v17
    v_lshl_add_u32 v16, v2, 3, v16
    v_lshl_add_u32 v17, v16, 8, v17
    v_and_b32 v16, 3, v0
    v_lshl_add_u32 v5, v16, 3, v17
    v_xor_b32 v6, 32, v5
    v_mov_b32 v7, 130048
    v_mov_b32 v16, 0x3f803f80
    v_mov_b32 v17, 0x3f803f80
    v_mov_b32 v18, 150528
    ds_write_b64 v18, v[16:17]
    ds_write_b64 v18, v[16:17] offset:8
    v_mov_b64 v[20:21], 0
    v_mov_b64 v[22:23], 0
    s_nop 1
    v_mfma_f32_32x32x16_bf16 v[80:95], v[20:23], v[20:23], 0
    v_mfma_f32_32x32x16_bf16 v[96:111], v[20:23], v[20:23], 0
    v_mfma_f32_32x32x16_bf16 v[112:127], v[20:23], v[20:23], 0
    v_mfma_f32_32x32x16_bf16 v[128:143], v[20:23], v[20:23], 0
    v_mfma_f32_32x32x16_bf16 v[144:159], v[20:23], v[20:23], 0
    v_mfma_f32_32x32x16_bf16 v[160:175], v[20:23], v[20:23], 0
    v_mfma_f32_32x32x16_bf16 v[176:191], v[20:23], v[20:23], 0
    v_mfma_f32_32x32x16_bf16 v[192:207], v[20:23], v[20:23], 0
    v_mfma_f32_32x32x16_bf16 v[208:223], v[20:23], v[20:23], 0
    v_mfma_f32_32x32x16_bf16 v[224:239], v[20:23], v[20:23], 0
    v_mfma_f32_32x32x16_bf16 v[240:255], v[20:23], v[20:23], 0
    s_lshl_b32 s40, s48, 2
    s_add_u32 s40, s40, s33
    s_lshl_b32 s40, s40, 10
    s_add_u32 s40, s40, s54
    v_lshl_add_u32 v13, v0, 4, s40
    s_mov_b32 s50, 0
    s_mov_b32 s51, 67584
    s_mov_b32 s53, 0
    s_mov_b32 s52, 0
    v_mov_b32 v8, v3
    v_add_u32 v11, s51, v5
    v_add_u32 v12, s51, v6
    s_waitcnt lgkmcnt(0)
    s_mov_b32 s28, s74
    s_mov_b32 s29, s75
    s_mov_b32 s30, 9732096
    s_mov_b32 s31, 0x00020000
    s_add_u32 s64, s74, 9764864
    s_addc_u32 s65, s75, 0
    s_mov_b32 s66, 3072
    s_mov_b32 s67, 0x00020000
    s_mov_b32 s40, 0x0fffffff
    s_mov_b32 s41, 0x0fffffff
    s_waitcnt vmcnt(0)
    v_lshlrev_b32 v48, 16, v32
    v_and_b32 v49, s32, v32
    v_lshlrev_b32 v50, 16, v33
    v_and_b32 v51, s32, v33
    v_lshlrev_b32 v52, 16, v34
    v_and_b32 v53, s32, v34
    v_lshlrev_b32 v54, 16, v35
    v_and_b32 v55, s32, v35
    v_lshlrev_b32 v56, 16, v36
    v_and_b32 v57, s32, v36
    v_lshlrev_b32 v58, 16, v37
    v_and_b32 v59, s32, v37
    v_lshlrev_b32 v60, 16, v38
    v_and_b32 v61, s32, v38
    v_lshlrev_b32 v62, 16, v39
    v_and_b32 v63, s32, v39
    v_pk_add_f32 v[64:65], v[48:49], v[50:51]
    v_pk_add_f32 v[64:65], v[64:65], v[52:53]
    v_pk_add_f32 v[64:65], v[64:65], v[54:55]
    v_pk_add_f32 v[64:65], v[64:65], v[56:57]
    v_pk_add_f32 v[64:65], v[64:65], v[58:59]
    v_pk_add_f32 v[64:65], v[64:65], v[60:61]
    v_pk_add_f32 v[64:65], v[64:65], v[62:63]
    v_add_f32 v64, v64, v65
    s_nop 1
    v_add_f32_dpp v64, v64, v64 quad_perm:[1,0,3,2] row_mask:0xf bank_mask:0xf
    s_nop 1
    v_add_f32_dpp v64, v64, v64 quad_perm:[2,3,0,1] row_mask:0xf bank_mask:0xf
    s_nop 1
    v_add_f32_dpp v64, v64, v64 row_half_mirror row_mask:0xf bank_mask:0xf
    s_nop 1
    v_add_f32_dpp v64, v64, v64 row_mirror row_mask:0xf bank_mask:0xf
    v_mov_b32 v66, v64
    s_nop 1
    v_permlane16_swap_b32 v64, v66
    v_add_f32 v64, v64, v66
    v_mul_f32 v64, 0xbb124925, v64
    v_pk_add_f32 v[48:49], v[48:49], v[64:65] op_sel:[0,0] op_sel_hi:[1,0]
    v_pk_add_f32 v[50:51], v[50:51], v[64:65] op_sel:[0,0] op_sel_hi:[1,0]
    v_pk_add_f32 v[52:53], v[52:53], v[64:65] op_sel:[0,0] op_sel_hi:[1,0]
    v_pk_add_f32 v[54:55], v[54:55], v[64:65] op_sel:[0,0] op_sel_hi:[1,0]
    v_pk_add_f32 v[56:57], v[56:57], v[64:65] op_sel:[0,0] op_sel_hi:[1,0]
    v_pk_add_f32 v[58:59], v[58:59], v[64:65] op_sel:[0,0] op_sel_hi:[1,0]
    v_pk_add_f32 v[60:61], v[60:61], v[64:65] op_sel:[0,0] op_sel_hi:[1,0]
    v_pk_add_f32 v[62:63], v[62:63], v[64:65] op_sel:[0,0] op_sel_hi:[1,0]
    v_pk_mul_f32 v[66:67], v[48:49], v[48:49]
    v_pk_fma_f32 v[66:67], v[50:51], v[50:51], v[66:67]
    v_pk_fma_f32 v[66:67], v[52:53], v[52:53], v[66:67]
    v_pk_fma_f32 v[66:67], v[54:55], v[54:55], v[66:67]
    v_pk_fma_f32 v[66:67], v[56:57], v[56:57], v[66:67]
    v_pk_fma_f32 v[66:67], v[58:59], v[58:59], v[66:67]
    v_pk_fma_f32 v[66:67], v[60:61], v[60:61], v[66:67]
    v_pk_fma_f32 v[66:67], v[62:63], v[62:63], v[66:67]
    v_add_f32 v65, v66, v67
    v_cndmask_b32 v65, 0, v65, s[40:41]
    s_nop 1
    v_add_f32_dpp v65, v65, v65 quad_perm:[1,0,3,2] row_mask:0xf bank_mask:0xf
    s_nop 1
    v_add_f32_dpp v65, v65, v65 quad_perm:[2,3,0,1] row_mask:0xf bank_mask:0xf
    s_nop 1
    v_add_f32_dpp v65, v65, v65 row_half_mirror row_mask:0xf bank_mask:0xf
    s_nop 1
    v_add_f32_dpp v65, v65, v65 row_mirror row_mask:0xf bank_mask:0xf
    v_mov_b32 v66, v65
    s_nop 1
    v_permlane16_swap_b32 v65, v66
    v_add_f32 v65, v65, v66
    v_mul_f32 v65, 0x3b124925, v65
    v_cvt_pk_bf16_f32 v65, v65, v65
    v_and_b32 v65, 0xffff0000, v65
    v_add_f32 v65, 0x3727c5ac, v65
    v_cvt_pk_bf16_f32 v65, v65, v65
    v_and_b32 v65, 0xffff0000, v65
    v_sqrt_f32 v65, v65
    s_lshl_b32 s40, s33, 3
    s_add_u32 s40, s40, 157968
    v_lshrrev_b32 v66, 5, v0
    v_lshl_add_u32 v66, v66, 2, s40
    v_cvt_pk_bf16_f32 v64, v64, v65
    ds_write_b32 v66, v64
    s_waitcnt lgkmcnt(0)
    v_cndmask_b32 v10, v8, v7, s[34:35]
    s_barrier
    ds_read_b64_tr_b16 v[48:49], v11 offset:0
    ds_read_b64_tr_b16 v[50:51], v11 offset:1024
    ds_read_b64_tr_b16 v[52:53], v12 offset:0
    ds_read_b64_tr_b16 v[54:55], v12 offset:1024
    ds_read_b64_tr_b16 v[56:57], v11 offset:8192
    ds_read_b64_tr_b16 v[58:59], v11 offset:9216
    ds_read_b64_tr_b16 v[60:61], v12 offset:8192
    ds_read_b64_tr_b16 v[62:63], v12 offset:9216
    ds_read_b128 v[24:27], v10 offset:20480
    ds_read_b128 v[28:31], v8 offset:0
    ds_read_b128 v[32:35], v8 offset:2048
    ds_read_b128 v[36:39], v8 offset:4096
    ds_read_b128 v[40:43], v8 offset:6144
    ds_read_b128 v[44:47], v8 offset:8192
    s_waitcnt lgkmcnt(0)
G_LOOP:
    s_barrier
    v_mfma_f32_16x16x32_bf16 v[240:243], v[48:51], v[24:27], v[240:243]
    s_add_u32 s51, s51, 16384
    s_cmp_ge_u32 s51, 149504
    v_mfma_f32_16x16x32_bf16 v[244:247], v[52:55], v[24:27], v[244:247]
    s_cselect_b32 s51, 67584, s51
    v_add_u32 v11, s51, v5
    v_mfma_f32_16x16x32_bf16 v[248:251], v[56:59], v[24:27], v[248:251]
    v_add_u32 v12, s51, v6
    v_mfma_f32_16x16x32_bf16 v[252:255], v[60:63], v[24:27], v[252:255]
    ds_read_b128 v[24:27], v8 offset:10240
    v_mfma_f32_16x16x32_bf16 v[80:83], v[48:51], v[28:31], v[80:83]
    v_mfma_f32_16x16x32_bf16 v[84:87], v[52:55], v[28:31], v[84:87]
    ds_read_b64_tr_b16 v[64:65], v11 offset:0
    v_mfma_f32_16x16x32_bf16 v[88:91], v[56:59], v[28:31], v[88:91]
    v_mfma_f32_16x16x32_bf16 v[92:95], v[60:63], v[28:31], v[92:95]
    ds_read_b128 v[28:31], v8 offset:12288
    s_waitcnt lgkmcnt(5)
    v_mfma_f32_16x16x32_bf16 v[96:99], v[48:51], v[32:35], v[96:99]
    v_mfma_f32_16x16x32_bf16 v[100:103], v[52:55], v[32:35], v[100:103]
    ds_read_b64_tr_b16 v[66:67], v11 offset:1024
    v_mfma_f32_16x16x32_bf16 v[104:107], v[56:59], v[32:35], v[104:107]
    v_mfma_f32_16x16x32_bf16 v[108:111], v[60:63], v[32:35], v[108:111]
    ds_read_b128 v[32:35], v8 offset:14336
    s_waitcnt lgkmcnt(6)
    v_mfma_f32_16x16x32_bf16 v[112:115], v[48:51], v[36:39], v[112:115]
    v_add_u32 v9, s50, v4
    v_mfma_f32_16x16x32_bf16 v[116:119], v[52:55], v[36:39], v[116:119]
    ds_read_b64_tr_b16 v[68:69], v12 offset:0
    v_mfma_f32_16x16x32_bf16 v[120:123], v[56:59], v[36:39], v[120:123]
    v_mfma_f32_16x16x32_bf16 v[124:127], v[60:63], v[36:39], v[124:127]
    ds_read_b128 v[36:39], v8 offset:16384
    s_waitcnt lgkmcnt(7)
    v_mfma_f32_16x16x32_bf16 v[128:131], v[48:51], v[40:43], v[128:131]
    v_cndmask_b32 v10, v9, v7, s[34:35]
    v_mfma_f32_16x16x32_bf16 v[132:135], v[52:55], v[40:43], v[132:135]
    ds_read_b64_tr_b16 v[70:71], v12 offset:1024
    v_mfma_f32_16x16x32_bf16 v[136:139], v[56:59], v[40:43], v[136:139]
    v_mfma_f32_16x16x32_bf16 v[140:143], v[60:63], v[40:43], v[140:143]
    ds_read_b128 v[40:43], v8 offset:18432
    v_mfma_f32_16x16x32_bf16 v[144:147], v[48:51], v[44:47], v[144:147]
    v_mfma_f32_16x16x32_bf16 v[148:151], v[52:55], v[44:47], v[148:151]
    ds_read_b64_tr_b16 v[72:73], v11 offset:8192
    v_mfma_f32_16x16x32_bf16 v[152:155], v[56:59], v[44:47], v[152:155]
    v_mfma_f32_16x16x32_bf16 v[156:159], v[60:63], v[44:47], v[156:159]
    ds_read_b128 v[44:47], v9 offset:8192
    s_waitcnt lgkmcnt(10)
    v_mfma_f32_16x16x32_bf16 v[160:163], v[48:51], v[24:27], v[160:163]
    v_mfma_f32_16x16x32_bf16 v[164:167], v[52:55], v[24:27], v[164:167]
    ds_read_b64_tr_b16 v[74:75], v11 offset:9216
    v_mfma_f32_16x16x32_bf16 v[168:171], v[56:59], v[24:27], v[168:171]
    v_mfma_f32_16x16x32_bf16 v[172:175], v[60:63], v[24:27], v[172:175]
    ds_read_b128 v[24:27], v10 offset:20480
    s_waitcnt lgkmcnt(10)
    v_mfma_f32_16x16x32_bf16 v[176:179], v[48:51], v[28:31], v[176:179]
    v_mfma_f32_16x16x32_bf16 v[180:183], v[52:55], v[28:31], v[180:183]
    ds_read_b64_tr_b16 v[76:77], v12 offset:8192
    v_mfma_f32_16x16x32_bf16 v[184:187], v[56:59], v[28:31], v[184:187]
    v_mfma_f32_16x16x32_bf16 v[188:191], v[60:63], v[28:31], v[188:191]
    ds_read_b128 v[28:31], v9 offset:0
    s_waitcnt lgkmcnt(10)
    v_mfma_f32_16x16x32_bf16 v[192:195], v[48:51], v[32:35], v[192:195]
    v_mfma_f32_16x16x32_bf16 v[196:199], v[52:55], v[32:35], v[196:199]
    ds_read_b64_tr_b16 v[78:79], v12 offset:9216
    v_mfma_f32_16x16x32_bf16 v[200:203], v[56:59], v[32:35], v[200:203]
    v_mfma_f32_16x16x32_bf16 v[204:207], v[60:63], v[32:35], v[204:207]
    ds_read_b128 v[32:35], v9 offset:2048
    s_waitcnt lgkmcnt(10)
    v_mfma_f32_16x16x32_bf16 v[208:211], v[48:51], v[36:39], v[208:211]
    v_mfma_f32_16x16x32_bf16 v[212:215], v[52:55], v[36:39], v[212:215]
    v_mfma_f32_16x16x32_bf16 v[216:219], v[56:59], v[36:39], v[216:219]
    v_mfma_f32_16x16x32_bf16 v[220:223], v[60:63], v[36:39], v[220:223]
    ds_read_b128 v[36:39], v9 offset:4096
    s_waitcnt lgkmcnt(9)
    v_mfma_f32_16x16x32_bf16 v[224:227], v[48:51], v[40:43], v[224:227]
    v_mfma_f32_16x16x32_bf16 v[228:231], v[52:55], v[40:43], v[228:231]
    v_mfma_f32_16x16x32_bf16 v[232:235], v[56:59], v[40:43], v[232:235]
    v_mfma_f32_16x16x32_bf16 v[236:239], v[60:63], v[40:43], v[236:239]
    ds_read_b128 v[40:43], v9 offset:6144
    s_waitcnt lgkmcnt(3)
    s_barrier
    v_mfma_f32_16x16x32_bf16 v[240:243], v[64:67], v[24:27], v[240:243]
    s_add_u32 s51, s51, 16384
    s_cmp_ge_u32 s51, 149504
    v_mfma_f32_16x16x32_bf16 v[244:247], v[68:71], v[24:27], v[244:247]
    s_cselect_b32 s51, 67584, s51
    v_add_u32 v11, s51, v5
    v_mfma_f32_16x16x32_bf16 v[248:251], v[72:75], v[24:27], v[248:251]
    v_add_u32 v12, s51, v6
    v_mfma_f32_16x16x32_bf16 v[252:255], v[76:79], v[24:27], v[252:255]
    ds_read_b128 v[24:27], v9 offset:10240
    v_mfma_f32_16x16x32_bf16 v[80:83], v[64:67], v[28:31], v[80:83]
    v_mfma_f32_16x16x32_bf16 v[84:87], v[68:71], v[28:31], v[84:87]
    ds_read_b64_tr_b16 v[48:49], v11 offset:0
    v_mfma_f32_16x16x32_bf16 v[88:91], v[72:75], v[28:31], v[88:91]
    v_mfma_f32_16x16x32_bf16 v[92:95], v[76:79], v[28:31], v[92:95]
    ds_read_b128 v[28:31], v9 offset:12288
    s_waitcnt lgkmcnt(5)
    v_mfma_f32_16x16x32_bf16 v[96:99], v[64:67], v[32:35], v[96:99]
    s_add_u32 s50, s50, 22528
    s_cmp_ge_u32 s50, 67584
    v_mfma_f32_16x16x32_bf16 v[100:103], v[68:71], v[32:35], v[100:103]
    ds_read_b64_tr_b16 v[50:51], v11 offset:1024
    v_mfma_f32_16x16x32_bf16 v[104:107], v[72:75], v[32:35], v[104:107]
    s_cselect_b32 s50, 0, s50
    v_mfma_f32_16x16x32_bf16 v[108:111], v[76:79], v[32:35], v[108:111]
    ds_read_b128 v[32:35], v9 offset:14336
    s_waitcnt lgkmcnt(6)
    v_mfma_f32_16x16x32_bf16 v[112:115], v[64:67], v[36:39], v[112:115]
    v_add_u32 v8, s50, v3
    v_mfma_f32_16x16x32_bf16 v[116:119], v[68:71], v[36:39], v[116:119]
    ds_read_b64_tr_b16 v[52:53], v12 offset:0
    v_mfma_f32_16x16x32_bf16 v[120:123], v[72:75], v[36:39], v[120:123]
    v_mfma_f32_16x16x32_bf16 v[124:127], v[76:79], v[36:39], v[124:127]
    ds_read_b128 v[36:39], v9 offset:16384
    s_waitcnt lgkmcnt(7)
    v_mfma_f32_16x16x32_bf16 v[128:131], v[64:67], v[40:43], v[128:131]
    v_cndmask_b32 v10, v8, v7, s[34:35]
    v_mfma_f32_16x16x32_bf16 v[132:135], v[68:71], v[40:43], v[132:135]
    ds_read_b64_tr_b16 v[54:55], v12 offset:1024
    v_mfma_f32_16x16x32_bf16 v[136:139], v[72:75], v[40:43], v[136:139]
    v_mfma_f32_16x16x32_bf16 v[140:143], v[76:79], v[40:43], v[140:143]
    ds_read_b128 v[40:43], v9 offset:18432
    v_mfma_f32_16x16x32_bf16 v[144:147], v[64:67], v[44:47], v[144:147]
    v_mfma_f32_16x16x32_bf16 v[148:151], v[68:71], v[44:47], v[148:151]
    ds_read_b64_tr_b16 v[56:57], v11 offset:8192
    v_mfma_f32_16x16x32_bf16 v[152:155], v[72:75], v[44:47], v[152:155]
    v_mfma_f32_16x16x32_bf16 v[156:159], v[76:79], v[44:47], v[156:159]
    ds_read_b128 v[44:47], v8 offset:8192
    s_waitcnt lgkmcnt(10)
    v_mfma_f32_16x16x32_bf16 v[160:163], v[64:67], v[24:27], v[160:163]
    v_mfma_f32_16x16x32_bf16 v[164:167], v[68:71], v[24:27], v[164:167]
    ds_read_b64_tr_b16 v[58:59], v11 offset:9216
    v_mfma_f32_16x16x32_bf16 v[168:171], v[72:75], v[24:27], v[168:171]
    v_mfma_f32_16x16x32_bf16 v[172:175], v[76:79], v[24:27], v[172:175]
    ds_read_b128 v[24:27], v10 offset:20480
    s_waitcnt lgkmcnt(10)
    v_mfma_f32_16x16x32_bf16 v[176:179], v[64:67], v[28:31], v[176:179]
    v_mfma_f32_16x16x32_bf16 v[180:183], v[68:71], v[28:31], v[180:183]
    ds_read_b64_tr_b16 v[60:61], v12 offset:8192
    v_mfma_f32_16x16x32_bf16 v[184:187], v[72:75], v[28:31], v[184:187]
    v_mfma_f32_16x16x32_bf16 v[188:191], v[76:79], v[28:31], v[188:191]
    ds_read_b128 v[28:31], v8 offset:0
    s_waitcnt lgkmcnt(10)
    v_mfma_f32_16x16x32_bf16 v[192:195], v[64:67], v[32:35], v[192:195]
    v_mfma_f32_16x16x32_bf16 v[196:199], v[68:71], v[32:35], v[196:199]
    ds_read_b64_tr_b16 v[62:63], v12 offset:9216
    v_mfma_f32_16x16x32_bf16 v[200:203], v[72:75], v[32:35], v[200:203]
    v_mfma_f32_16x16x32_bf16 v[204:207], v[76:79], v[32:35], v[204:207]
    ds_read_b128 v[32:35], v8 offset:2048
    s_waitcnt lgkmcnt(10)
    v_mfma_f32_16x16x32_bf16 v[208:211], v[64:67], v[36:39], v[208:211]
    v_mfma_f32_16x16x32_bf16 v[212:215], v[68:71], v[36:39], v[212:215]
    v_mfma_f32_16x16x32_bf16 v[216:219], v[72:75], v[36:39], v[216:219]
    v_mfma_f32_16x16x32_bf16 v[220:223], v[76:79], v[36:39], v[220:223]
    ds_read_b128 v[36:39], v8 offset:4096
    s_waitcnt lgkmcnt(9)
    v_mfma_f32_16x16x32_bf16 v[224:227], v[64:67], v[40:43], v[224:227]
    s_add_u32 s52, s52, 1
    s_cmp_lt_u32 s52, 6
    v_mfma_f32_16x16x32_bf16 v[228:231], v[68:71], v[40:43], v[228:231]
    v_mfma_f32_16x16x32_bf16 v[232:235], v[72:75], v[40:43], v[232:235]
    v_mfma_f32_16x16x32_bf16 v[236:239], v[76:79], v[40:43], v[236:239]
    ds_read_b128 v[40:43], v8 offset:6144
    s_waitcnt lgkmcnt(3)
    s_cbranch_scc1 G_LOOP
    s_barrier
    v_mfma_f32_16x16x32_bf16 v[240:243], v[48:51], v[24:27], v[240:243]
    v_add_u32 v11, 116736, v5
    v_add_u32 v12, 116736, v6
    v_add_u32 v9, s50, v4
    v_mfma_f32_16x16x32_bf16 v[244:247], v[52:55], v[24:27], v[244:247]
    v_cndmask_b32 v10, v9, v7, s[34:35]
    ds_read_b64_tr_b16 v[64:65], v11 offset:0
    ds_read_b64_tr_b16 v[66:67], v11 offset:1024
    v_mfma_f32_16x16x32_bf16 v[248:251], v[56:59], v[24:27], v[248:251]
    ds_read_b64_tr_b16 v[68:69], v12 offset:0
    ds_read_b64_tr_b16 v[70:71], v12 offset:1024
    ds_read_b64_tr_b16 v[72:73], v11 offset:8192
    v_mfma_f32_16x16x32_bf16 v[252:255], v[60:63], v[24:27], v[252:255]
    ds_read_b64_tr_b16 v[74:75], v11 offset:9216
    ds_read_b64_tr_b16 v[76:77], v12 offset:8192
    ds_read_b64_tr_b16 v[78:79], v12 offset:9216
    ds_read_b128 v[24:27], v10 offset:20480
    v_mfma_f32_16x16x32_bf16 v[80:83], v[48:51], v[28:31], v[80:83]
    v_lshlrev_b32 v4, 2, v1
    v_add_u32 v4, 149504, v4
    ds_read_b32 v16, v4 offset:0
    v_mfma_f32_16x16x32_bf16 v[84:87], v[52:55], v[28:31], v[84:87]
    ds_read_b32 v17, v4 offset:64
    ds_read_b32 v18, v4 offset:128
    ds_read_b32 v19, v4 offset:192
    v_mfma_f32_16x16x32_bf16 v[88:91], v[56:59], v[28:31], v[88:91]
    ds_read_b32 v20, v4 offset:256
    ds_read_b32 v21, v4 offset:320
    ds_read_b32 v22, v4 offset:384
    v_mfma_f32_16x16x32_bf16 v[92:95], v[60:63], v[28:31], v[92:95]
    ds_read_b32 v23, v4 offset:448
    ds_read_b32 v3, v4 offset:512
    ds_read_b32 v5, v4 offset:576
    ds_read_b128 v[28:31], v9 offset:0
    s_waitcnt lgkmcnt(14)
    v_mfma_f32_16x16x32_bf16 v[96:99], v[48:51], v[32:35], v[96:99]
    ds_read_b32 v6, v4 offset:640
    v_mfma_f32_16x16x32_bf16 v[100:103], v[52:55], v[32:35], v[100:103]
    v_mfma_f32_16x16x32_bf16 v[104:107], v[56:59], v[32:35], v[104:107]
    v_mfma_f32_16x16x32_bf16 v[108:111], v[60:63], v[32:35], v[108:111]
    ds_read_b128 v[32:35], v9 offset:2048
    v_mfma_f32_16x16x32_bf16 v[112:115], v[48:51], v[36:39], v[112:115]
    v_mfma_f32_16x16x32_bf16 v[116:119], v[52:55], v[36:39], v[116:119]
    v_mfma_f32_16x16x32_bf16 v[120:123], v[56:59], v[36:39], v[120:123]
    v_mfma_f32_16x16x32_bf16 v[124:127], v[60:63], v[36:39], v[124:127]
    ds_read_b128 v[36:39], v9 offset:4096
    s_waitcnt lgkmcnt(14)
    s_barrier
    v_mfma_f32_16x16x32_bf16 v[240:243], v[64:67], v[24:27], v[240:243]
    v_mfma_f32_16x16x32_bf16 v[244:247], v[68:71], v[24:27], v[244:247]
    v_mfma_f32_16x16x32_bf16 v[248:251], v[72:75], v[24:27], v[248:251]
    v_mfma_f32_16x16x32_bf16 v[252:255], v[76:79], v[24:27], v[252:255]
    ds_read_b128 v[24:27], v8 offset:10240
    s_waitcnt lgkmcnt(4)
    v_mfma_f32_16x16x32_bf16 v[80:83], v[64:67], v[28:31], v[80:83]
    v_mfma_f32_16x16x32_bf16 v[84:87], v[68:71], v[28:31], v[84:87]
    v_mfma_f32_16x16x32_bf16 v[88:91], v[72:75], v[28:31], v[88:91]
    v_mfma_f32_16x16x32_bf16 v[92:95], v[76:79], v[28:31], v[92:95]
    ds_read_b128 v[28:31], v9 offset:6144
    v_mfma_f32_16x16x32_bf16 v[128:131], v[48:51], v[40:43], v[128:131]
    v_mfma_f32_16x16x32_bf16 v[132:135], v[52:55], v[40:43], v[132:135]
    v_mfma_f32_16x16x32_bf16 v[136:139], v[56:59], v[40:43], v[136:139]
    v_mfma_f32_16x16x32_bf16 v[140:143], v[60:63], v[40:43], v[140:143]
    ds_read_b128 v[40:43], v8 offset:12288
    s_waitcnt lgkmcnt(4)
    v_mfma_f32_16x16x32_bf16 v[96:99], v[64:67], v[32:35], v[96:99]
    v_fmac_f32_dpp v80, v240, v16 row_newbcast:15 row_mask:0xf bank_mask:0xf
    v_fmac_f32_dpp v81, v241, v16 row_newbcast:15 row_mask:0xf bank_mask:0xf
    v_mfma_f32_16x16x32_bf16 v[100:103], v[68:71], v[32:35], v[100:103]
    v_fmac_f32_dpp v82, v242, v16 row_newbcast:15 row_mask:0xf bank_mask:0xf
    v_fmac_f32_dpp v83, v243, v16 row_newbcast:15 row_mask:0xf bank_mask:0xf
    v_fmac_f32_dpp v84, v244, v16 row_newbcast:15 row_mask:0xf bank_mask:0xf
    v_mfma_f32_16x16x32_bf16 v[104:107], v[72:75], v[32:35], v[104:107]
    v_fmac_f32_dpp v85, v245, v16 row_newbcast:15 row_mask:0xf bank_mask:0xf
    v_fmac_f32_dpp v86, v246, v16 row_newbcast:15 row_mask:0xf bank_mask:0xf
    v_fmac_f32_dpp v87, v247, v16 row_newbcast:15 row_mask:0xf bank_mask:0xf
    v_mfma_f32_16x16x32_bf16 v[108:111], v[76:79], v[32:35], v[108:111]
    v_fmac_f32_dpp v88, v248, v16 row_newbcast:15 row_mask:0xf bank_mask:0xf
    v_fmac_f32_dpp v89, v249, v16 row_newbcast:15 row_mask:0xf bank_mask:0xf
    v_fmac_f32_dpp v90, v250, v16 row_newbcast:15 row_mask:0xf bank_mask:0xf
    ds_read_b128 v[32:35], v9 offset:8192
    v_mfma_f32_16x16x32_bf16 v[144:147], v[48:51], v[44:47], v[144:147]
    v_fmac_f32_dpp v91, v251, v16 row_newbcast:15 row_mask:0xf bank_mask:0xf
    v_fmac_f32_dpp v92, v252, v16 row_newbcast:15 row_mask:0xf bank_mask:0xf
    v_fmac_f32_dpp v93, v253, v16 row_newbcast:15 row_mask:0xf bank_mask:0xf
    v_mfma_f32_16x16x32_bf16 v[148:151], v[52:55], v[44:47], v[148:151]
    v_fmac_f32_dpp v94, v254, v16 row_newbcast:15 row_mask:0xf bank_mask:0xf
    v_fmac_f32_dpp v95, v255, v16 row_newbcast:15 row_mask:0xf bank_mask:0xf
    v_mul_f32 v80, v80, v88
    v_mfma_f32_16x16x32_bf16 v[152:155], v[56:59], v[44:47], v[152:155]
    v_mul_f32 v81, v81, v89
    v_mul_f32 v82, v82, v90
    v_mul_f32 v83, v83, v91
    v_mfma_f32_16x16x32_bf16 v[156:159], v[60:63], v[44:47], v[156:159]
    v_mul_f32 v84, v84, v92
    v_mul_f32 v85, v85, v93
    v_mul_f32 v86, v86, v94
    ds_read_b128 v[44:47], v8 offset:14336
    s_waitcnt lgkmcnt(5)
    v_mfma_f32_16x16x32_bf16 v[112:115], v[64:67], v[36:39], v[112:115]
    v_mul_f32 v87, v87, v95
    v_cvt_pk_bf16_f32 v88, v80, v81
    v_cvt_pk_bf16_f32 v89, v82, v83
    v_mfma_f32_16x16x32_bf16 v[116:119], v[68:71], v[36:39], v[116:119]
    v_cvt_pk_bf16_f32 v90, v84, v85
    v_cvt_pk_bf16_f32 v91, v86, v87
    s_mov_b32 s40, 0
    v_mfma_f32_16x16x32_bf16 v[120:123], v[72:75], v[36:39], v[120:123]
    buffer_store_dwordx4 v[88:91], v13, s[28:31], s40 offen sc1
    v_fmac_f32_dpp v96, v240, v17 row_newbcast:15 row_mask:0xf bank_mask:0xf
    v_fmac_f32_dpp v97, v241, v17 row_newbcast:15 row_mask:0xf bank_mask:0xf
    v_mfma_f32_16x16x32_bf16 v[124:127], v[76:79], v[36:39], v[124:127]
    v_fmac_f32_dpp v98, v242, v17 row_newbcast:15 row_mask:0xf bank_mask:0xf
    v_fmac_f32_dpp v99, v243, v17 row_newbcast:15 row_mask:0xf bank_mask:0xf
    v_fmac_f32_dpp v100, v244, v17 row_newbcast:15 row_mask:0xf bank_mask:0xf
    ds_read_b128 v[36:39], v9 offset:10240
    s_waitcnt lgkmcnt(5)
    v_mfma_f32_16x16x32_bf16 v[160:163], v[48:51], v[24:27], v[160:163]
    v_fmac_f32_dpp v101, v245, v17 row_newbcast:15 row_mask:0xf bank_mask:0xf
    v_fmac_f32_dpp v102, v246, v17 row_newbcast:15 row_mask:0xf bank_mask:0xf
    v_fmac_f32_dpp v103, v247, v17 row_newbcast:15 row_mask:0xf bank_mask:0xf
    v_mfma_f32_16x16x32_bf16 v[164:167], v[52:55], v[24:27], v[164:167]
    v_fmac_f32_dpp v104, v248, v17 row_newbcast:15 row_mask:0xf bank_mask:0xf
    v_fmac_f32_dpp v105, v249, v17 row_newbcast:15 row_mask:0xf bank_mask:0xf
    v_fmac_f32_dpp v106, v250, v17 row_newbcast:15 row_mask:0xf bank_mask:0xf
    v_mfma_f32_16x16x32_bf16 v[168:171], v[56:59], v[24:27], v[168:171]
    v_fmac_f32_dpp v107, v251, v17 row_newbcast:15 row_mask:0xf bank_mask:0xf
    v_fmac_f32_dpp v108, v252, v17 row_newbcast:15 row_mask:0xf bank_mask:0xf
    v_fmac_f32_dpp v109, v253, v17 row_newbcast:15 row_mask:0xf bank_mask:0xf
    v_mfma_f32_16x16x32_bf16 v[172:175], v[60:63], v[24:27], v[172:175]
    v_fmac_f32_dpp v110, v254, v17 row_newbcast:15 row_mask:0xf bank_mask:0xf
    v_fmac_f32_dpp v111, v255, v17 row_newbcast:15 row_mask:0xf bank_mask:0xf
    v_mul_f32 v96, v96, v104
    ds_read_b128 v[24:27], v8 offset:16384
    s_waitcnt lgkmcnt(5)
    v_mfma_f32_16x16x32_bf16 v[128:131], v[64:67], v[28:31], v[128:131]
    v_mul_f32 v97, v97, v105
    v_mul_f32 v98, v98, v106
    v_mul_f32 v99, v99, v107
    v_mfma_f32_16x16x32_bf16 v[132:135], v[68:71], v[28:31], v[132:135]
    v_mul_f32 v100, v100, v108
    v_mul_f32 v101, v101, v109
    v_mul_f32 v102, v102, v110
    v_mfma_f32_16x16x32_bf16 v[136:139], v[72:75], v[28:31], v[136:139]
    v_mul_f32 v103, v103, v111
    v_cvt_pk_bf16_f32 v104, v96, v97
    v_cvt_pk_bf16_f32 v105, v98, v99
    v_mfma_f32_16x16x32_bf16 v[140:143], v[76:79], v[28:31], v[140:143]
    v_cvt_pk_bf16_f32 v106, v100, v101
    v_cvt_pk_bf16_f32 v107, v102, v103
    s_mov_b32 s40, 57344
    ds_read_b128 v[28:31], v9 offset:12288
    s_waitcnt lgkmcnt(5)
    v_mfma_f32_16x16x32_bf16 v[176:179], v[48:51], v[40:43], v[176:179]
    buffer_store_dwordx4 v[104:107], v13, s[28:31], s40 offen sc1
    v_fmac_f32_dpp v112, v240, v18 row_newbcast:15 row_mask:0xf bank_mask:0xf
    v_fmac_f32_dpp v113, v241, v18 row_newbcast:15 row_mask:0xf bank_mask:0xf
    v_mfma_f32_16x16x32_bf16 v[180:183], v[52:55], v[40:43], v[180:183]
    v_fmac_f32_dpp v114, v242, v18 row_newbcast:15 row_mask:0xf bank_mask:0xf
    v_fmac_f32_dpp v115, v243, v18 row_newbcast:15 row_mask:0xf bank_mask:0xf
    v_fmac_f32_dpp v116, v244, v18 row_newbcast:15 row_mask:0xf bank_mask:0xf
    v_mfma_f32_16x16x32_bf16 v[184:187], v[56:59], v[40:43], v[184:187]
    v_fmac_f32_dpp v117, v245, v18 row_newbcast:15 row_mask:0xf bank_mask:0xf
    v_fmac_f32_dpp v118, v246, v18 row_newbcast:15 row_mask:0xf bank_mask:0xf
    v_fmac_f32_dpp v119, v247, v18 row_newbcast:15 row_mask:0xf bank_mask:0xf
    v_mfma_f32_16x16x32_bf16 v[188:191], v[60:63], v[40:43], v[188:191]
    v_fmac_f32_dpp v120, v248, v18 row_newbcast:15 row_mask:0xf bank_mask:0xf
    v_fmac_f32_dpp v121, v249, v18 row_newbcast:15 row_mask:0xf bank_mask:0xf
    v_fmac_f32_dpp v122, v250, v18 row_newbcast:15 row_mask:0xf bank_mask:0xf
    ds_read_b128 v[40:43], v8 offset:18432
    s_waitcnt lgkmcnt(5)
    v_mfma_f32_16x16x32_bf16 v[144:147], v[64:67], v[32:35], v[144:147]
    v_fmac_f32_dpp v123, v251, v18 row_newbcast:15 row_mask:0xf bank_mask:0xf
    v_fmac_f32_dpp v124, v252, v18 row_newbcast:15 row_mask:0xf bank_mask:0xf
    v_fmac_f32_dpp v125, v253, v18 row_newbcast:15 row_mask:0xf bank_mask:0xf
    v_mfma_f32_16x16x32_bf16 v[148:151], v[68:71], v[32:35], v[148:151]
    v_fmac_f32_dpp v126, v254, v18 row_newbcast:15 row_mask:0xf bank_mask:0xf
    v_fmac_f32_dpp v127, v255, v18 row_newbcast:15 row_mask:0xf bank_mask:0xf
    v_mul_f32 v112, v112, v120
    v_mfma_f32_16x16x32_bf16 v[152:155], v[72:75], v[32:35], v[152:155]
    v_mul_f32 v113, v113, v121
    v_mul_f32 v114, v114, v122
    v_mul_f32 v115, v115, v123
    v_mfma_f32_16x16x32_bf16 v[156:159], v[76:79], v[32:35], v[156:159]
    v_mul_f32 v116, v116, v124
    v_mul_f32 v117, v117, v125
    v_mul_f32 v118, v118, v126
    ds_read_b128 v[32:35], v9 offset:14336
    s_waitcnt lgkmcnt(5)
    v_mfma_f32_16x16x32_bf16 v[192:195], v[48:51], v[44:47], v[192:195]
    v_mul_f32 v119, v119, v127
    v_cvt_pk_bf16_f32 v120, v112, v113
    v_cvt_pk_bf16_f32 v121, v114, v115
    v_mfma_f32_16x16x32_bf16 v[196:199], v[52:55], v[44:47], v[196:199]
    v_cvt_pk_bf16_f32 v122, v116, v117
    v_cvt_pk_bf16_f32 v123, v118, v119
    s_mov_b32 s40, 114688
    v_mfma_f32_16x16x32_bf16 v[200:203], v[56:59], v[44:47], v[200:203]
    buffer_store_dwordx4 v[120:123], v13, s[28:31], s40 offen sc1
    v_fmac_f32_dpp v128, v240, v19 row_newbcast:15 row_mask:0xf bank_mask:0xf
    v_fmac_f32_dpp v129, v241, v19 row_newbcast:15 row_mask:0xf bank_mask:0xf
    v_mfma_f32_16x16x32_bf16 v[204:207], v[60:63], v[44:47], v[204:207]
    v_fmac_f32_dpp v130, v242, v19 row_newbcast:15 row_mask:0xf bank_mask:0xf
    v_fmac_f32_dpp v131, v243, v19 row_newbcast:15 row_mask:0xf bank_mask:0xf
    v_fmac_f32_dpp v132, v244, v19 row_newbcast:15 row_mask:0xf bank_mask:0xf
    ds_read_b128 v[44:47], v9 offset:16384
    s_waitcnt lgkmcnt(5)
    v_mfma_f32_16x16x32_bf16 v[160:163], v[64:67], v[36:39], v[160:163]
    v_fmac_f32_dpp v133, v245, v19 row_newbcast:15 row_mask:0xf bank_mask:0xf
    v_fmac_f32_dpp v134, v246, v19 row_newbcast:15 row_mask:0xf bank_mask:0xf
    v_fmac_f32_dpp v135, v247, v19 row_newbcast:15 row_mask:0xf bank_mask:0xf
    v_mfma_f32_16x16x32_bf16 v[164:167], v[68:71], v[36:39], v[164:167]
    v_fmac_f32_dpp v136, v248, v19 row_newbcast:15 row_mask:0xf bank_mask:0xf
    v_fmac_f32_dpp v137, v249, v19 row_newbcast:15 row_mask:0xf bank_mask:0xf
    v_fmac_f32_dpp v138, v250, v19 row_newbcast:15 row_mask:0xf bank_mask:0xf
    v_mfma_f32_16x16x32_bf16 v[168:171], v[72:75], v[36:39], v[168:171]
    v_fmac_f32_dpp v139, v251, v19 row_newbcast:15 row_mask:0xf bank_mask:0xf
    v_fmac_f32_dpp v140, v252, v19 row_newbcast:15 row_mask:0xf bank_mask:0xf
    v_fmac_f32_dpp v141, v253, v19 row_newbcast:15 row_mask:0xf bank_mask:0xf
    v_mfma_f32_16x16x32_bf16 v[172:175], v[76:79], v[36:39], v[172:175]
    v_fmac_f32_dpp v142, v254, v19 row_newbcast:15 row_mask:0xf bank_mask:0xf
    v_fmac_f32_dpp v143, v255, v19 row_newbcast:15 row_mask:0xf bank_mask:0xf
    v_mul_f32 v128, v128, v136
    ds_read_b128 v[36:39], v9 offset:18432
    s_waitcnt lgkmcnt(5)
    v_mfma_f32_16x16x32_bf16 v[208:211], v[48:51], v[24:27], v[208:211]
    v_mul_f32 v129, v129, v137
    v_mul_f32 v130, v130, v138
    v_mul_f32 v131, v131, v139
    v_mfma_f32_16x16x32_bf16 v[212:215], v[52:55], v[24:27], v[212:215]
    v_mul_f32 v132, v132, v140
    v_mul_f32 v133, v133, v141
    v_mul_f32 v134, v134, v142
    v_mfma_f32_16x16x32_bf16 v[216:219], v[56:59], v[24:27], v[216:219]
    v_mul_f32 v135, v135, v143
    v_cvt_pk_bf16_f32 v136, v128, v129
    v_cvt_pk_bf16_f32 v137, v130, v131
    v_mfma_f32_16x16x32_bf16 v[220:223], v[60:63], v[24:27], v[220:223]
    v_cvt_pk_bf16_f32 v138, v132, v133
    v_cvt_pk_bf16_f32 v139, v134, v135
    s_mov_b32 s40, 172032
    s_waitcnt lgkmcnt(4)
    v_mfma_f32_16x16x32_bf16 v[176:179], v[64:67], v[28:31], v[176:179]
    buffer_store_dwordx4 v[136:139], v13, s[28:31], s40 offen sc1
    v_fmac_f32_dpp v144, v240, v20 row_newbcast:15 row_mask:0xf bank_mask:0xf
    v_fmac_f32_dpp v145, v241, v20 row_newbcast:15 row_mask:0xf bank_mask:0xf
    v_mfma_f32_16x16x32_bf16 v[180:183], v[68:71], v[28:31], v[180:183]
    v_fmac_f32_dpp v146, v242, v20 row_newbcast:15 row_mask:0xf bank_mask:0xf
    v_fmac_f32_dpp v147, v243, v20 row_newbcast:15 row_mask:0xf bank_mask:0xf
    v_fmac_f32_dpp v148, v244, v20 row_newbcast:15 row_mask:0xf bank_mask:0xf
    v_mfma_f32_16x16x32_bf16 v[184:187], v[72:75], v[28:31], v[184:187]
    v_fmac_f32_dpp v149, v245, v20 row_newbcast:15 row_mask:0xf bank_mask:0xf
    v_fmac_f32_dpp v150, v246, v20 row_newbcast:15 row_mask:0xf bank_mask:0xf
    v_fmac_f32_dpp v151, v247, v20 row_newbcast:15 row_mask:0xf bank_mask:0xf
    v_mfma_f32_16x16x32_bf16 v[188:191], v[76:79], v[28:31], v[188:191]
    v_fmac_f32_dpp v152, v248, v20 row_newbcast:15 row_mask:0xf bank_mask:0xf
    v_fmac_f32_dpp v153, v249, v20 row_newbcast:15 row_mask:0xf bank_mask:0xf
    v_fmac_f32_dpp v154, v250, v20 row_newbcast:15 row_mask:0xf bank_mask:0xf
    s_waitcnt lgkmcnt(3)
    v_mfma_f32_16x16x32_bf16 v[224:227], v[48:51], v[40:43], v[224:227]
    v_fmac_f32_dpp v155, v251, v20 row_newbcast:15 row_mask:0xf bank_mask:0xf
    v_fmac_f32_dpp v156, v252, v20 row_newbcast:15 row_mask:0xf bank_mask:0xf
    v_fmac_f32_dpp v157, v253, v20 row_newbcast:15 row_mask:0xf bank_mask:0xf
    v_mfma_f32_16x16x32_bf16 v[228:231], v[52:55], v[40:43], v[228:231]
    v_fmac_f32_dpp v158, v254, v20 row_newbcast:15 row_mask:0xf bank_mask:0xf
    v_fmac_f32_dpp v159, v255, v20 row_newbcast:15 row_mask:0xf bank_mask:0xf
    v_mul_f32 v144, v144, v152
    v_mfma_f32_16x16x32_bf16 v[232:235], v[56:59], v[40:43], v[232:235]
    v_mul_f32 v145, v145, v153
    v_mul_f32 v146, v146, v154
    v_mul_f32 v147, v147, v155
    v_mfma_f32_16x16x32_bf16 v[236:239], v[60:63], v[40:43], v[236:239]
    v_mul_f32 v148, v148, v156
    v_mul_f32 v149, v149, v157
    v_mul_f32 v150, v150, v158
    s_waitcnt lgkmcnt(2)
    v_mfma_f32_16x16x32_bf16 v[192:195], v[64:67], v[32:35], v[192:195]
    v_mul_f32 v151, v151, v159
    v_cvt_pk_bf16_f32 v152, v144, v145
    v_cvt_pk_bf16_f32 v153, v146, v147
    v_mfma_f32_16x16x32_bf16 v[196:199], v[68:71], v[32:35], v[196:199]
    v_cvt_pk_bf16_f32 v154, v148, v149
    v_cvt_pk_bf16_f32 v155, v150, v151
    s_mov_b32 s40, 229376
    v_mfma_f32_16x16x32_bf16 v[200:203], v[72:75], v[32:35], v[200:203]
    buffer_store_dwordx4 v[152:155], v13, s[28:31], s40 offen sc1
    v_fmac_f32_dpp v160, v240, v21 row_newbcast:15 row_mask:0xf bank_mask:0xf
    v_fmac_f32_dpp v161, v241, v21 row_newbcast:15 row_mask:0xf bank_mask:0xf
    v_mfma_f32_16x16x32_bf16 v[204:207], v[76:79], v[32:35], v[204:207]
    v_fmac_f32_dpp v162, v242, v21 row_newbcast:15 row_mask:0xf bank_mask:0xf
    v_fmac_f32_dpp v163, v243, v21 row_newbcast:15 row_mask:0xf bank_mask:0xf
    v_fmac_f32_dpp v164, v244, v21 row_newbcast:15 row_mask:0xf bank_mask:0xf
    s_waitcnt lgkmcnt(1)
    v_mfma_f32_16x16x32_bf16 v[208:211], v[64:67], v[44:47], v[208:211]
    v_fmac_f32_dpp v165, v245, v21 row_newbcast:15 row_mask:0xf bank_mask:0xf
    v_fmac_f32_dpp v166, v246, v21 row_newbcast:15 row_mask:0xf bank_mask:0xf
    v_fmac_f32_dpp v167, v247, v21 row_newbcast:15 row_mask:0xf bank_mask:0xf
    v_mfma_f32_16x16x32_bf16 v[212:215], v[68:71], v[44:47], v[212:215]
    v_fmac_f32_dpp v168, v248, v21 row_newbcast:15 row_mask:0xf bank_mask:0xf
    v_fmac_f32_dpp v169, v249, v21 row_newbcast:15 row_mask:0xf bank_mask:0xf
    v_fmac_f32_dpp v170, v250, v21 row_newbcast:15 row_mask:0xf bank_mask:0xf
    v_mfma_f32_16x16x32_bf16 v[216:219], v[72:75], v[44:47], v[216:219]
    v_fmac_f32_dpp v171, v251, v21 row_newbcast:15 row_mask:0xf bank_mask:0xf
    v_fmac_f32_dpp v172, v252, v21 row_newbcast:15 row_mask:0xf bank_mask:0xf
    v_fmac_f32_dpp v173, v253, v21 row_newbcast:15 row_mask:0xf bank_mask:0xf
    v_mfma_f32_16x16x32_bf16 v[220:223], v[76:79], v[44:47], v[220:223]
    v_fmac_f32_dpp v174, v254, v21 row_newbcast:15 row_mask:0xf bank_mask:0xf
    v_fmac_f32_dpp v175, v255, v21 row_newbcast:15 row_mask:0xf bank_mask:0xf
    v_mul_f32 v160, v160, v168
    s_waitcnt lgkmcnt(0)
    v_mfma_f32_16x16x32_bf16 v[224:227], v[64:67], v[36:39], v[224:227]
    v_mul_f32 v161, v161, v169
    v_mul_f32 v162, v162, v170
    v_mul_f32 v163, v163, v171
    v_mfma_f32_16x16x32_bf16 v[228:231], v[68:71], v[36:39], v[228:231]
    v_mul_f32 v164, v164, v172
    v_mul_f32 v165, v165, v173
    v_mul_f32 v166, v166, v174
    v_mfma_f32_16x16x32_bf16 v[232:235], v[72:75], v[36:39], v[232:235]
    v_mul_f32 v167, v167, v175
    v_cvt_pk_bf16_f32 v168, v160, v161
    v_cvt_pk_bf16_f32 v169, v162, v163
    v_mfma_f32_16x16x32_bf16 v[236:239], v[76:79], v[36:39], v[236:239]
    v_cvt_pk_bf16_f32 v170, v164, v165
    v_cvt_pk_bf16_f32 v171, v166, v167
    s_mov_b32 s40, 286720
    s_load_dword s39, s[72:73], 0
    buffer_store_dwordx4 v[168:171], v13, s[28:31], s40 offen sc1
    s_nop 7
    v_mov_b32_dpp v48, v240 row_newbcast:15 row_mask:0xf bank_mask:0xf
    v_mov_b32_dpp v49, v241 row_newbcast:15 row_mask:0xf bank_mask:0xf
    v_mov_b32_dpp v50, v242 row_newbcast:15 row_mask:0xf bank_mask:0xf
    v_mov_b32_dpp v51, v243 row_newbcast:15 row_mask:0xf bank_mask:0xf
    v_mov_b32_dpp v52, v244 row_newbcast:15 row_mask:0xf bank_mask:0xf
    v_mov_b32_dpp v53, v245 row_newbcast:15 row_mask:0xf bank_mask:0xf
    v_mov_b32_dpp v54, v246 row_newbcast:15 row_mask:0xf bank_mask:0xf
    v_mov_b32_dpp v55, v247 row_newbcast:15 row_mask:0xf bank_mask:0xf
    v_mov_b32_dpp v56, v248 row_newbcast:15 row_mask:0xf bank_mask:0xf
    v_mov_b32_dpp v57, v249 row_newbcast:15 row_mask:0xf bank_mask:0xf
    v_mov_b32_dpp v58, v250 row_newbcast:15 row_mask:0xf bank_mask:0xf
    v_mov_b32_dpp v59, v251 row_newbcast:15 row_mask:0xf bank_mask:0xf
    v_mov_b32_dpp v60, v252 row_newbcast:15 row_mask:0xf bank_mask:0xf
    v_mov_b32_dpp v61, v253 row_newbcast:15 row_mask:0xf bank_mask:0xf
    v_mov_b32_dpp v62, v254 row_newbcast:15 row_mask:0xf bank_mask:0xf
    v_mov_b32_dpp v63, v255 row_newbcast:15 row_mask:0xf bank_mask:0xf
    v_pk_fma_f32 v[176:177], v[48:49], v[22:23], v[176:177] op_sel:[0,0,0] op_sel_hi:[1,0,1]
    v_pk_fma_f32 v[178:179], v[50:51], v[22:23], v[178:179] op_sel:[0,0,0] op_sel_hi:[1,0,1]
    v_pk_fma_f32 v[180:181], v[52:53], v[22:23], v[180:181] op_sel:[0,0,0] op_sel_hi:[1,0,1]
    v_pk_fma_f32 v[182:183], v[54:55], v[22:23], v[182:183] op_sel:[0,0,0] op_sel_hi:[1,0,1]
    v_pk_fma_f32 v[184:185], v[56:57], v[22:23], v[184:185] op_sel:[0,0,0] op_sel_hi:[1,0,1]
    v_pk_fma_f32 v[186:187], v[58:59], v[22:23], v[186:187] op_sel:[0,0,0] op_sel_hi:[1,0,1]
    v_pk_fma_f32 v[188:189], v[60:61], v[22:23], v[188:189] op_sel:[0,0,0] op_sel_hi:[1,0,1]
    v_pk_fma_f32 v[190:191], v[62:63], v[22:23], v[190:191] op_sel:[0,0,0] op_sel_hi:[1,0,1]
    v_pk_mul_f32 v[176:177], v[176:177], v[184:185]
    v_pk_mul_f32 v[178:179], v[178:179], v[186:187]
    v_pk_mul_f32 v[180:181], v[180:181], v[188:189]
    v_pk_mul_f32 v[182:183], v[182:183], v[190:191]
    v_cvt_pk_bf16_f32 v184, v176, v177
    v_cvt_pk_bf16_f32 v185, v178, v179
    v_cvt_pk_bf16_f32 v186, v180, v181
    v_cvt_pk_bf16_f32 v187, v182, v183
    s_mov_b32 s40, 344064
    buffer_store_dwordx4 v[184:187], v13, s[28:31], s40 offen sc1
    v_pk_fma_f32 v[192:193], v[48:49], v[22:23], v[192:193] op_sel:[0,1,0] op_sel_hi:[1,1,1]
    v_pk_fma_f32 v[194:195], v[50:51], v[22:23], v[194:195] op_sel:[0,1,0] op_sel_hi:[1,1,1]
    v_pk_fma_f32 v[196:197], v[52:53], v[22:23], v[196:197] op_sel:[0,1,0] op_sel_hi:[1,1,1]
    v_pk_fma_f32 v[198:199], v[54:55], v[22:23], v[198:199] op_sel:[0,1,0] op_sel_hi:[1,1,1]
    v_pk_fma_f32 v[200:201], v[56:57], v[22:23], v[200:201] op_sel:[0,1,0] op_sel_hi:[1,1,1]
    v_pk_fma_f32 v[202:203], v[58:59], v[22:23], v[202:203] op_sel:[0,1,0] op_sel_hi:[1,1,1]
    v_pk_fma_f32 v[204:205], v[60:61], v[22:23], v[204:205] op_sel:[0,1,0] op_sel_hi:[1,1,1]
    v_pk_fma_f32 v[206:207], v[62:63], v[22:23], v[206:207] op_sel:[0,1,0] op_sel_hi:[1,1,1]
    v_pk_mul_f32 v[192:193], v[192:193], v[200:201]
    v_pk_mul_f32 v[194:195], v[194:195], v[202:203]
    v_pk_mul_f32 v[196:197], v[196:197], v[204:205]
    v_pk_mul_f32 v[198:199], v[198:199], v[206:207]
    v_cvt_pk_bf16_f32 v200, v192, v193
    v_cvt_pk_bf16_f32 v201, v194, v195
    v_cvt_pk_bf16_f32 v202, v196, v197
    v_cvt_pk_bf16_f32 v203, v198, v199
    s_mov_b32 s40, 401408
    buffer_store_dwordx4 v[200:203], v13, s[28:31], s40 offen sc1
    v_pk_fma_f32 v[208:209], v[48:49], v[2:3], v[208:209] op_sel:[0,1,0] op_sel_hi:[1,1,1]
    v_pk_fma_f32 v[210:211], v[50:51], v[2:3], v[210:211] op_sel:[0,1,0] op_sel_hi:[1,1,1]
    v_pk_fma_f32 v[212:213], v[52:53], v[2:3], v[212:213] op_sel:[0,1,0] op_sel_hi:[1,1,1]
    v_pk_fma_f32 v[214:215], v[54:55], v[2:3], v[214:215] op_sel:[0,1,0] op_sel_hi:[1,1,1]
    v_pk_fma_f32 v[216:217], v[56:57], v[2:3], v[216:217] op_sel:[0,1,0] op_sel_hi:[1,1,1]
    v_pk_fma_f32 v[218:219], v[58:59], v[2:3], v[218:219] op_sel:[0,1,0] op_sel_hi:[1,1,1]
    v_pk_fma_f32 v[220:221], v[60:61], v[2:3], v[220:221] op_sel:[0,1,0] op_sel_hi:[1,1,1]
    v_pk_fma_f32 v[222:223], v[62:63], v[2:3], v[222:223] op_sel:[0,1,0] op_sel_hi:[1,1,1]
    v_pk_mul_f32 v[208:209], v[208:209], v[216:217]
    v_pk_mul_f32 v[210:211], v[210:211], v[218:219]
    v_pk_mul_f32 v[212:213], v[212:213], v[220:221]
    v_pk_mul_f32 v[214:215], v[214:215], v[222:223]
    v_cvt_pk_bf16_f32 v216, v208, v209
    v_cvt_pk_bf16_f32 v217, v210, v211
    v_cvt_pk_bf16_f32 v218, v212, v213
    v_cvt_pk_bf16_f32 v219, v214, v215
    s_mov_b32 s40, 458752
    buffer_store_dwordx4 v[216:219], v13, s[28:31], s40 offen sc1
    v_pk_fma_f32 v[224:225], v[48:49], v[4:5], v[224:225] op_sel:[0,1,0] op_sel_hi:[1,1,1]
    v_pk_fma_f32 v[226:227], v[50:51], v[4:5], v[226:227] op_sel:[0,1,0] op_sel_hi:[1,1,1]
    v_pk_fma_f32 v[228:229], v[52:53], v[4:5], v[228:229] op_sel:[0,1,0] op_sel_hi:[1,1,1]
    v_pk_fma_f32 v[230:231], v[54:55], v[4:5], v[230:231] op_sel:[0,1,0] op_sel_hi:[1,1,1]
    v_pk_fma_f32 v[232:233], v[56:57], v[4:5], v[232:233] op_sel:[0,1,0] op_sel_hi:[1,1,1]
    v_pk_fma_f32 v[234:235], v[58:59], v[4:5], v[234:235] op_sel:[0,1,0] op_sel_hi:[1,1,1]
    v_pk_fma_f32 v[236:237], v[60:61], v[4:5], v[236:237] op_sel:[0,1,0] op_sel_hi:[1,1,1]
    v_pk_fma_f32 v[238:239], v[62:63], v[4:5], v[238:239] op_sel:[0,1,0] op_sel_hi:[1,1,1]
    v_pk_mul_f32 v[224:225], v[224:225], v[232:233]
    v_pk_mul_f32 v[226:227], v[226:227], v[234:235]
    v_pk_mul_f32 v[228:229], v[228:229], v[236:237]
    v_pk_mul_f32 v[230:231], v[230:231], v[238:239]
    v_cvt_pk_bf16_f32 v232, v224, v225
    v_cvt_pk_bf16_f32 v233, v226, v227
    v_cvt_pk_bf16_f32 v234, v228, v229
    v_cvt_pk_bf16_f32 v235, v230, v231
    s_mov_b32 s40, 516096
    buffer_store_dwordx4 v[232:235], v13, s[28:31], s40 offen sc1
    v_pk_fma_f32 v[240:241], v[48:49], v[6:7], v[240:241] op_sel:[0,0,0] op_sel_hi:[1,0,1]
    v_pk_fma_f32 v[242:243], v[50:51], v[6:7], v[242:243] op_sel:[0,0,0] op_sel_hi:[1,0,1]
    v_pk_fma_f32 v[244:245], v[52:53], v[6:7], v[244:245] op_sel:[0,0,0] op_sel_hi:[1,0,1]
    v_pk_fma_f32 v[246:247], v[54:55], v[6:7], v[246:247] op_sel:[0,0,0] op_sel_hi:[1,0,1]
    v_pk_fma_f32 v[248:249], v[56:57], v[6:7], v[248:249] op_sel:[0,0,0] op_sel_hi:[1,0,1]
    v_pk_fma_f32 v[250:251], v[58:59], v[6:7], v[250:251] op_sel:[0,0,0] op_sel_hi:[1,0,1]
    v_pk_fma_f32 v[252:253], v[60:61], v[6:7], v[252:253] op_sel:[0,0,0] op_sel_hi:[1,0,1]
    v_pk_fma_f32 v[254:255], v[62:63], v[6:7], v[254:255] op_sel:[0,0,0] op_sel_hi:[1,0,1]
    v_pk_mul_f32 v[240:241], v[240:241], v[248:249]
    v_pk_mul_f32 v[242:243], v[242:243], v[250:251]
    v_pk_mul_f32 v[244:245], v[244:245], v[252:253]
    v_pk_mul_f32 v[246:247], v[246:247], v[254:255]
    v_cvt_pk_bf16_f32 v248, v240, v241
    v_cvt_pk_bf16_f32 v249, v242, v243
    v_cvt_pk_bf16_f32 v250, v244, v245
    v_cvt_pk_bf16_f32 v251, v246, v247
    s_mov_b32 s40, 573440
    buffer_store_dwordx4 v[248:251], v13, s[28:31], s40 offen sc1
    s_waitcnt lgkmcnt(0)
    s_lshr_b32 s40, s33, 1
    s_and_b32 s41, s33, 1
    s_lshl_b32 s42, s78, 1
    s_add_u32 s42, s42, s40
    s_lshl_b32 s44, s42, 5
    s_mul_i32 s42, s42, 114688
    v_and_b32 v10, 1, v2
    v_mul_u32_u24 v11, 57344, v10
    v_lshl_add_u32 v11, v1, 4, v11
    v_lshrrev_b32 v9, 5, v0
    v_lshl_add_u32 v11, v9, 8, v11
    s_lshl_b32 s43, s41, 11
    s_add_u32 s43, s43, s42
    v_add_u32 v3, s43, v11
    v_and_b32 v11, 31, v0
    v_add_u32 v11, s44, v11
    v_mul_u32_u24 v12, 745, v11
    v_lshrrev_b32 v12, 17, v12
    v_sub_u32 v11, v11, v12
    v_min_u32 v11, 2047, v11
    v_mul_u32_u24 v12, 690, v11
    v_lshrrev_b32 v12, 16, v12
    v_mul_u32_u24 v4, 95, v12
    v_sub_u32 v11, v11, v4
    v_mul_u32_u24 v4, 6, v12
    v_lshrrev_b32 v12, 4, v11
    v_add_u32 v4, v4, v12
    v_lshlrev_b32 v4, 14, v4
    v_and_b32 v11, 15, v11
    v_lshl_add_u32 v4, v11, 4, v4
    v_lshl_add_u32 v4, v9, 8, v4
    s_lshl_b32 s43, s41, 13
    s_add_u32 s43, s43, 7569408
    v_add_u32 v4, s43, v4
    v_bfe_u32 v11, v0, 2, 2
    v_lshl_add_u32 v7, v9, 2, v11
    v_lshlrev_b32 v7, 7, v7
    v_and_b32 v11, 2, v11
    v_or_b32 v11, v11, v9
    v_xor_b32 v11, v11, v10
    v_lshl_add_u32 v7, v11, 5, v7
    v_and_b32 v11, 3, v0
    v_lshl_add_u32 v7, v11, 3, v7
    s_lshl_b32 s43, s41, 12
    v_add_u32 v5, s43, v7
    v_xor_b32 v6, 64, v5
    v_add_u32 v7, 49152, v5
    v_add_u32 v8, 49152, v6
    s_mul_i32 s43, s33, 8448
    s_add_u32 s43, s43, 16384
    v_lshl_add_u32 v9, v0, 4, s43
    v_mov_b32 v15, s39
    s_cmp_lg_u32 s39, 0
    s_cbranch_scc1 G_TAG_HAVE
    s_mov_b32 s44, 0
G_TAG_T_LOOP:
    global_load_dword v15, v14, s[72:73] sc1
G_TAG_T_CHK:
    s_add_u32 s44, s44, 1
    s_waitcnt vmcnt(0)
    v_readfirstlane_b32 s45, v15
    s_cmp_ge_u32 s44, 60000
    s_cbranch_scc1 G_TAG_T_DONE
    s_nop 1
    s_cmp_eq_u32 s45, 0
    s_cbranch_scc1 G_TAG_T_LOOP
G_TAG_T_DONE:
G_TAG_HAVE:
    s_waitcnt vmcnt(0)
    s_barrier
    s_cmp_lg_u32 s14, 0
    s_cbranch_scc1 G_FSET
    s_mov_b64 exec, 1
    buffer_store_dword v15, v14, s[64:67], s38 offen sc1
    s_mov_b64 exec, -1
G_FSET:
    s_barrier
    ds_read_b64_tr_b16 v[192:193], v7 offset:0
    ds_read_b64_tr_b16 v[194:195], v7 offset:2048
    ds_read_b64_tr_b16 v[196:197], v8 offset:0
    ds_read_b64_tr_b16 v[198:199], v8 offset:2048
    ds_read_b64_tr_b16 v[200:201], v7 offset:1024
    ds_read_b64_tr_b16 v[202:203], v7 offset:3072
    ds_read_b64_tr_b16 v[204:205], v8 offset:1024
    ds_read_b64_tr_b16 v[206:207], v8 offset:3072
    ds_read_b64_tr_b16 v[208:209], v7 offset:8192
    ds_read_b64_tr_b16 v[210:211], v7 offset:10240
    ds_read_b64_tr_b16 v[212:213], v8 offset:8192
    ds_read_b64_tr_b16 v[214:215], v8 offset:10240
    ds_read_b64_tr_b16 v[216:217], v7 offset:9216
    ds_read_b64_tr_b16 v[218:219], v7 offset:11264
    ds_read_b64_tr_b16 v[220:221], v8 offset:9216
    ds_read_b64_tr_b16 v[222:223], v8 offset:11264
    ds_read_b64_tr_b16 v[224:225], v7 offset:16384
    ds_read_b64_tr_b16 v[226:227], v7 offset:18432
    ds_read_b64_tr_b16 v[228:229], v8 offset:16384
    ds_read_b64_tr_b16 v[230:231], v8 offset:18432
    ds_read_b64_tr_b16 v[232:233], v7 offset:17408
    ds_read_b64_tr_b16 v[234:235], v7 offset:19456
    ds_read_b64_tr_b16 v[236:237], v8 offset:17408
    ds_read_b64_tr_b16 v[238:239], v8 offset:19456
    ds_read_b64_tr_b16 v[240:241], v7 offset:24576
    ds_read_b64_tr_b16 v[242:243], v7 offset:26624
    ds_read_b64_tr_b16 v[244:245], v8 offset:24576
    ds_read_b64_tr_b16 v[246:247], v8 offset:26624
    ds_read_b64_tr_b16 v[248:249], v7 offset:25600
    ds_read_b64_tr_b16 v[250:251], v7 offset:27648
    ds_read_b64_tr_b16 v[252:253], v8 offset:25600
    ds_read_b64_tr_b16 v[254:255], v8 offset:27648
    ds_read_b64_tr_b16 v[96:97], v7 offset:32768
    ds_read_b64_tr_b16 v[98:99], v7 offset:34816
    ds_read_b64_tr_b16 v[100:101], v8 offset:32768
    ds_read_b64_tr_b16 v[102:103], v8 offset:34816
    ds_read_b64_tr_b16 v[104:105], v7 offset:33792
    ds_read_b64_tr_b16 v[106:107], v7 offset:35840
    ds_read_b64_tr_b16 v[108:109], v8 offset:33792
    ds_read_b64_tr_b16 v[110:111], v8 offset:35840
    ds_read_b64_tr_b16 v[112:113], v7 offset:40960
    ds_read_b64_tr_b16 v[114:115], v7 offset:43008
    ds_read_b64_tr_b16 v[116:117], v8 offset:40960
    ds_read_b64_tr_b16 v[118:119], v8 offset:43008
    ds_read_b64_tr_b16 v[120:121], v7 offset:41984
    ds_read_b64_tr_b16 v[122:123], v7 offset:44032
    ds_read_b64_tr_b16 v[124:125], v8 offset:41984
    ds_read_b64_tr_b16 v[126:127], v8 offset:44032
    ds_read_b64_tr_b16 v[16:17], v7 offset:49152
    ds_read_b64_tr_b16 v[18:19], v7 offset:51200
    ds_read_b64_tr_b16 v[20:21], v8 offset:49152
    ds_read_b64_tr_b16 v[22:23], v8 offset:51200
    ds_read_b64_tr_b16 v[24:25], v7 offset:50176
    ds_read_b64_tr_b16 v[26:27], v7 offset:52224
    ds_read_b64_tr_b16 v[28:29], v8 offset:50176
    ds_read_b64_tr_b16 v[30:31], v8 offset:52224
    ds_read_b64_tr_b16 v[32:33], v7 offset:57344
    ds_read_b64_tr_b16 v[34:35], v7 offset:59392
    ds_read_b64_tr_b16 v[36:37], v8 offset:57344
    ds_read_b64_tr_b16 v[38:39], v8 offset:59392
    ds_read_b64_tr_b16 v[40:41], v7 offset:58368
    ds_read_b64_tr_b16 v[42:43], v7 offset:60416
    ds_read_b64_tr_b16 v[44:45], v8 offset:58368
    ds_read_b64_tr_b16 v[46:47], v8 offset:60416
    s_waitcnt lgkmcnt(0)
    s_barrier
    s_cmp_lg_u32 s14, 0
    s_cbranch_scc1 G_PH_DONE
    s_lshl_b32 s42, s78, 6
    s_add_u32 s43, s42, 63
    s_mul_i32 s40, s42, 5958
    s_lshr_b32 s40, s40, 20
    s_mul_i32 s41, s43, 5958
    s_lshr_b32 s41, s41, 20
    s_mov_b32 s43, 0x7f007f
    s_cmp_eq_u32 s40, s41
    s_cselect_b32 s42, 0x7f, s43
    s_lshl_b32 s40, s40, 7
    s_add_u32 s40, s40, 0
    v_and_b32 v12, 1, v2
    v_lshlrev_b32 v12, 7, v12
    v_lshl_add_u32 v12, v1, 2, v12
    s_mov_b32 s44, 0
G_PH_LOOP:
    buffer_load_dword v13, v12, s[64:67], s40 offen sc1
G_PH_CHK:
    s_add_u32 s44, s44, 1
    s_waitcnt vmcnt(0)
    v_cmp_eq_u32 vcc, v15, v13
    s_cmp_ge_u32 s44, 60000
    s_cbranch_scc1 G_PH_DONE
    s_nop 1
    s_andn2_b32 s45, s42, vcc_lo
    s_cbranch_scc1 G_PH_LOOP
G_PH_DONE:
    s_branch P2_COMPUTE
QH_CONT:
    s_waitcnt vmcnt(6)
    s_barrier
    s_add_u32 s24, s54, s52
    s_cmp_ge_u32 s33, 2
    s_cbranch_scc1 Q_XSKIP1
    s_add_u32 m0, s12, 51200
    s_add_u32 s43, s24, 171136
    buffer_load_dwordx4 v5, s[16:19], s43 offen lds
Q_XSKIP1:
    s_add_u32 m0, s12, 26624
    s_add_u32 s43, s54, s51
    buffer_load_dwordx4 v5, s[16:19], s43 offen lds
    s_add_u32 m0, s12, 30720
    s_add_u32 s43, s24, 28672
    buffer_load_dwordx4 v5, s[16:19], s43 offen lds
    s_add_u32 m0, s12, 34816
    s_add_u32 s43, s24, 57344
    buffer_load_dwordx4 v5, s[16:19], s43 offen lds
    s_add_u32 m0, s12, 38912
    s_add_u32 s43, s54, s53
    buffer_load_dwordx4 v5, s[16:19], s43 offen lds
    s_add_u32 m0, s12, 43008
    s_add_u32 s43, s24, 113792
    buffer_load_dwordx4 v5, s[16:19], s43 offen lds
    s_add_u32 m0, s12, 47104
    s_add_u32 s43, s24, 142464
    buffer_load_dwordx4 v5, s[16:19], s43 offen lds
    s_add_u32 s54, s54, 128
    s_cmp_ge_u32 s54, 896
    s_cselect_b32 s54, 0, s54
    s_waitcnt vmcnt(9)
    s_barrier
    s_add_u32 m0, s12, 116736
    s_add_u32 s43, s55, 0
    buffer_load_dwordx4 v6, s[20:23], s43 offen lds
    s_add_u32 m0, s12, 120832
    s_add_u32 s43, s55, 896
    buffer_load_dwordx4 v6, s[20:23], s43 offen lds
    s_add_u32 m0, s12, 124928
    s_add_u32 s43, s55, 1792
    buffer_load_dwordx4 v6, s[20:23], s43 offen lds
    s_add_u32 s55, s55, 86016
    s_cmp_ge_u32 s55, 1204224
    s_cselect_b32 s55, 0, s55
    s_add_u32 s24, s54, s52
    s_cmp_ge_u32 s33, 2
    s_cbranch_scc1 Q_XSKIP2
    s_add_u32 m0, s12, 77824
    s_add_u32 s43, s24, 171136
    buffer_load_dwordx4 v5, s[16:19], s43 offen lds
Q_XSKIP2:
    s_add_u32 m0, s12, 53248
    s_add_u32 s43, s54, s51
    buffer_load_dwordx4 v5, s[16:19], s43 offen lds
    s_add_u32 m0, s12, 57344
    s_add_u32 s43, s24, 28672
    buffer_load_dwordx4 v5, s[16:19], s43 offen lds
    s_add_u32 m0, s12, 61440
    s_add_u32 s43, s24, 57344
    buffer_load_dwordx4 v5, s[16:19], s43 offen lds
    s_lshl_b32 s40, s50, 2
    s_add_u32 s40, s40, s33
    s_mul_i32 s41, s40, 37
    s_lshr_b32 s41, s41, 9
    s_mul_i32 s42, s41, 14
    s_sub_u32 s42, s40, s42
    s_mul_i32 s42, s42, 86016
    s_mov_b32 s28, s6
    s_mov_b32 s29, s7
    s_mov_b32 s30, 1204224
    s_mov_b32 s31, 0x00020000
    s_mul_i32 s43, s41, 896
    s_add_u32 s42, s42, s43
    s_mul_i32 s43, s48, 112
    s_add_u32 s42, s42, s43
    v_lshrrev_b32 v10, 1, v0
    v_mul_u32_u24 v10, 2688, v10
    v_and_b32 v11, 1, v0
    v_mul_u32_u24 v11, 108, v11
    s_mov_b32 m0, 157712
    v_add_u32 v10, v10, v11
    buffer_load_dword v10, s[28:31], s42 offen lds
    s_lshl_b32 s40, s2, 3
    s_add_u32 s40, s40, s3
    s_cmp_lt_u32 s40, 196
    s_cselect_b32 s28, s68, s76
    s_cselect_b32 s29, s69, s77
    s_mov_b32 s41, 401408
    s_cselect_b32 s30, 1605632, s41
    s_cselect_b32 s41, 0, 196
    s_mov_b32 s31, 0x00020000
    s_sub_u32 s41, s40, s41
    s_lshl_b32 s41, s41, 13
    s_lshl_b32 s40, s33, 11
    s_add_u32 s41, s41, s40
    s_mov_b32 m0, 157712
    v_lshlrev_b32 v10, 7, v1
    buffer_load_dword v10, s[28:31], s41 offen lds
    s_add_u32 s64, s74, 9764864
    s_addc_u32 s65, s75, 0
    s_mov_b32 s66, 3072
    s_mov_b32 s67, 0x00020000
    s_add_u32 s28, s74, 9732096
    s_addc_u32 s29, s75, 0
    s_mov_b32 s30, 32768
    s_mov_b32 s31, 0x00020000
    s_lshl_b32 s40, s33, 6
    v_add_u32 v10, s40, v0
    v_lshlrev_b32 v8, 3, v10
    v_add_u32 v8, 153600, v8
    v_cmp_le_u32 vcc, 112, v10
    s_sub_i32 s40, s49, 16
    v_add_u32 v11, s40, v10
    v_subbrev_co_u32 v11, vcc, 0, v11, vcc
    v_cmp_gt_u32 vcc, 208, v10
    v_min_u32 v11, 0x10000, v11
    v_lshlrev_b32 v11, 4, v11
    v_mov_b32 v10, 1073741824
    v_cndmask_b32 v9, v10, v11, vcc
    v_and_b32 v10, 1, v2
    v_lshlrev_b32 v10, 2, v10
    v_and_b32 v11, 2, v2
    v_or_b32 v10, v10, v11
    v_xor_b32 v10, v10, v4
    s_lshl_b32 s41, s33, 3
    v_add_u32 v11, s41, v3
    v_mul_u32_u24 v60, 896, v11
    v_lshl_add_u32 v60, v10, 4, v60
    s_lshl_b32 s41, s79, 7
    v_add_u32 v60, s41, v60
    v_cmp_le_u32 vcc, 28, v11
    v_mov_b32 v10, 1073741824
    s_cmp_lt_u32 s79, 7
    s_mov_b32 s56, s68
    s_mov_b32 s57, s69
    s_cselect_b32 s58, 1605632, 0
    s_mov_b32 s59, 0x00020000
    s_mov_b32 s60, s76
    s_mov_b32 s61, s77
    s_cselect_b32 s62, 401408, 0
    s_mov_b32 s63, 0x00020000
    v_cndmask_b32 v61, v60, v10, vcc
    s_waitcnt vmcnt(8)
    s_barrier
    s_add_u32 m0, s12, 65536
    s_add_u32 s43, s54, s53
    buffer_load_dwordx4 v5, s[16:19], s43 offen lds
    s_add_u32 m0, s12, 69632
    s_add_u32 s43, s24, 113792
    buffer_load_dwordx4 v5, s[16:19], s43 offen lds
    s_add_u32 m0, s12, 73728
    s_add_u32 s43, s24, 142464
    buffer_load_dwordx4 v5, s[16:19], s43 offen lds
    s_add_u32 s54, s54, 128
    s_cmp_ge_u32 s54, 896
    s_cselect_b32 s54, 0, s54
    s_add_u32 m0, s12, 129024
    s_add_u32 s43, s55, 0
    buffer_load_dwordx4 v6, s[20:23], s43 offen lds
    s_add_u32 m0, s12, 133120
    s_add_u32 s43, s55, 896
    buffer_load_dwordx4 v6, s[20:23], s43 offen lds
    s_add_u32 m0, s12, 137216
    s_add_u32 s43, s55, 1792
    buffer_load_dwordx4 v6, s[20:23], s43 offen lds
    s_add_u32 s55, s55, 86016
    s_add_u32 m0, s12, 141312
    s_add_u32 s43, s55, 0
    buffer_load_dwordx4 v6, s[20:23], s43 offen lds
    s_waitcnt vmcnt(12)
    s_barrier
    s_add_u32 m0, s12, 145408
    s_add_u32 s43, s55, 896
    buffer_load_dwordx4 v6, s[20:23], s43 offen lds
    s_add_u32 m0, s12, 149504
    s_add_u32 s43, s55, 1792
    buffer_load_dwordx4 v6, s[20:23], s43 offen lds
    s_add_u32 s55, s55, 86016
    s_cmp_ge_u32 s55, 1204224
    s_cselect_b32 s55, 0, s55
    s_add_u32 s24, s54, s52
    s_cmp_ge_u32 s33, 2
    s_cbranch_scc1 Q_XSKIP3
    s_add_u32 m0, s12, 24576
    s_add_u32 s43, s24, 171136
    buffer_load_dwordx4 v5, s[16:19], s43 offen lds
Q_XSKIP3:
    s_add_u32 m0, s12, 0
    s_add_u32 s43, s54, s51
    buffer_load_dwordx4 v5, s[16:19], s43 offen lds
    s_add_u32 m0, s12, 4096
    s_add_u32 s43, s24, 28672
    buffer_load_dwordx4 v5, s[16:19], s43 offen lds
    s_add_u32 m0, s12, 8192
    s_add_u32 s43, s24, 57344
    buffer_load_dwordx4 v5, s[16:19], s43 offen lds
    s_add_u32 m0, s12, 12288
    s_add_u32 s43, s54, s53
    buffer_load_dwordx4 v5, s[16:19], s43 offen lds
    s_waitcnt vmcnt(7)
    s_barrier
    s_add_u32 m0, s12, 16384
    s_add_u32 s43, s24, 113792
    buffer_load_dwordx4 v5, s[16:19], s43 offen lds
    s_add_u32 m0, s12, 20480
    s_add_u32 s43, s24, 142464
    buffer_load_dwordx4 v5, s[16:19], s43 offen lds
    s_add_u32 s54, s54, 128
    s_cmp_ge_u32 s54, 896
    s_cselect_b32 s54, 0, s54
    s_add_u32 m0, s12, 79872
    s_add_u32 s43, s55, 0
    buffer_load_dwordx4 v6, s[20:23], s43 offen lds
    s_add_u32 m0, s12, 83968
    s_add_u32 s43, s55, 896
    buffer_load_dwordx4 v6, s[20:23], s43 offen lds
    s_add_u32 m0, s12, 88064
    s_add_u32 s43, s55, 1792
    buffer_load_dwordx4 v6, s[20:23], s43 offen lds
    s_add_u32 s55, s55, 86016
    s_add_u32 m0, s12, 92160
    s_add_u32 s43, s55, 0
    buffer_load_dwordx4 v6, s[20:23], s43 offen lds
    s_add_u32 m0, s12, 96256
    s_add_u32 s43, s55, 896
    buffer_load_dwordx4 v6, s[20:23], s43 offen lds
    s_load_dword s39, s[72:73], 0
    s_waitcnt vmcnt(11)
    s_barrier
    s_add_u32 m0, s12, 100352
    s_add_u32 s43, s55, 1792
    buffer_load_dwordx4 v6, s[20:23], s43 offen lds
    s_add_u32 s55, s55, 86016
    s_cmp_ge_u32 s55, 1204224
    s_cselect_b32 s55, 0, s55
    s_add_u32 s24, s54, s52
    s_cmp_ge_u32 s33, 2
    s_cbranch_scc1 Q_XSKIP4
    s_add_u32 m0, s12, 51200
    s_add_u32 s43, s24, 171136
    buffer_load_dwordx4 v5, s[16:19], s43 offen lds
Q_XSKIP4:
    s_add_u32 m0, s12, 26624
    s_add_u32 s43, s54, s51
    buffer_load_dwordx4 v5, s[16:19], s43 offen lds
    s_add_u32 m0, s12, 30720
    s_add_u32 s43, s24, 28672
    buffer_load_dwordx4 v5, s[16:19], s43 offen lds
    s_add_u32 m0, s12, 34816
    s_add_u32 s43, s24, 57344
    buffer_load_dwordx4 v5, s[16:19], s43 offen lds
    s_add_u32 m0, s12, 38912
    s_add_u32 s43, s54, s53
    buffer_load_dwordx4 v5, s[16:19], s43 offen lds
    s_add_u32 m0, s12, 43008
    s_add_u32 s43, s24, 113792
    buffer_load_dwordx4 v5, s[16:19], s43 offen lds
    v_lshlrev_b32 v24, 2, v0
    v_add_u32 v24, 157968, v24
    ds_read_b32 v20, v24
    s_waitcnt lgkmcnt(0)
    v_mov_b32 v63, s39
    s_cmp_lg_u32 s39, 0
    s_cbranch_scc1 Q_SP_HAVE
    s_mov_b32 s44, 0
Q_SP_T_LOOP:
    global_load_dword v63, v62, s[72:73] sc1
Q_SP_T_CHK:
    s_add_u32 s44, s44, 1
    s_waitcnt vmcnt(0)
    v_readfirstlane_b32 s45, v63
    s_cmp_ge_u32 s44, 60000
    s_cbranch_scc1 Q_SP_T_DONE
    s_nop 1
    s_cmp_eq_u32 s45, 0
    s_cbranch_scc1 Q_SP_T_LOOP
Q_SP_T_DONE:
Q_SP_HAVE:
    s_cmp_lg_u32 s33, 0
    s_cbranch_scc1 Q_SP_SKIP
    s_lshl_b32 s40, s2, 3
    s_add_u32 s40, s40, s3
    s_lshl_b32 s40, s40, 7
    v_mov_b32 v21, v63
    v_mov_b32 v23, v63
    v_lshlrev_b32 v24, 4, v0
    v_mov_b32 v22, v20
    s_mov_b64 exec, 0xff
    buffer_store_dwordx4 v[20:23], v24, s[28:31], s40 offen sc1
    s_mov_b64 exec, -1
Q_SP_SKIP:
    s_waitcnt vmcnt(8)
    s_barrier
    s_add_u32 m0, s12, 47104
    s_add_u32 s43, s24, 142464
    buffer_load_dwordx4 v5, s[16:19], s43 offen lds
    s_add_u32 s54, s54, 128
    s_cmp_ge_u32 s54, 896
    s_cselect_b32 s54, 0, s54
    s_add_u32 m0, s12, 104448
    s_add_u32 s43, s55, 0
    buffer_load_dwordx4 v6, s[20:23], s43 offen lds
    s_add_u32 m0, s12, 108544
    s_add_u32 s43, s55, 896
    buffer_load_dwordx4 v6, s[20:23], s43 offen lds
    s_add_u32 m0, s12, 112640
    s_add_u32 s43, s55, 1792
    buffer_load_dwordx4 v6, s[20:23], s43 offen lds
    s_add_u32 s55, s55, 86016
    s_add_u32 m0, s12, 116736
    s_add_u32 s43, s55, 0
    buffer_load_dwordx4 v6, s[20:23], s43 offen lds
    s_add_u32 m0, s12, 120832
    s_add_u32 s43, s55, 896
    buffer_load_dwordx4 v6, s[20:23], s43 offen lds
    s_add_u32 m0, s12, 124928
    s_add_u32 s43, s55, 1792
    buffer_load_dwordx4 v6, s[20:23], s43 offen lds
    s_add_u32 s55, s55, 86016
    s_cmp_ge_u32 s55, 1204224
    s_cselect_b32 s55, 0, s55
    s_waitcnt vmcnt(12)
    s_barrier
    s_add_u32 s24, s54, s52
    s_cmp_ge_u32 s33, 2
    s_cbranch_scc1 Q_XSKIP5
    s_add_u32 m0, s12, 77824
    s_add_u32 s43, s24, 171136
    buffer_load_dwordx4 v5, s[16:19], s43 offen lds
Q_XSKIP5:
    s_add_u32 m0, s12, 53248
    s_add_u32 s43, s54, s51
    buffer_load_dwordx4 v5, s[16:19], s43 offen lds
    s_add_u32 m0, s12, 57344
    s_add_u32 s43, s24, 28672
    buffer_load_dwordx4 v5, s[16:19], s43 offen lds
    s_add_u32 m0, s12, 61440
    s_add_u32 s43, s24, 57344
    buffer_load_dwordx4 v5, s[16:19], s43 offen lds
    s_add_u32 m0, s12, 65536
    s_add_u32 s43, s54, s53
    buffer_load_dwordx4 v5, s[16:19], s43 offen lds
    s_add_u32 m0, s12, 69632
    s_add_u32 s43, s24, 113792
    buffer_load_dwordx4 v5, s[16:19], s43 offen lds
    s_add_u32 m0, s12, 73728
    s_add_u32 s43, s24, 142464
    buffer_load_dwordx4 v5, s[16:19], s43 offen lds
    s_add_u32 s54, s54, 128
    s_cmp_ge_u32 s54, 896
    s_cselect_b32 s54, 0, s54
    s_waitcnt vmcnt(9)
    s_barrier
    s_add_u32 m0, s12, 129024
    s_add_u32 s43, s55, 0
    buffer_load_dwordx4 v6, s[20:23], s43 offen lds
    s_add_u32 m0, s12, 133120
    s_add_u32 s43, s55, 896
    buffer_load_dwordx4 v6, s[20:23], s43 offen lds
    s_add_u32 m0, s12, 137216
    s_add_u32 s43, s55, 1792
    buffer_load_dwordx4 v6, s[20:23], s43 offen lds
    s_add_u32 s55, s55, 86016
    s_add_u32 m0, s12, 141312
    s_add_u32 s43, s55, 0
    buffer_load_dwordx4 v6, s[20:23], s43 offen lds
    s_add_u32 m0, s12, 145408
    s_add_u32 s43, s55, 896
    buffer_load_dwordx4 v6, s[20:23], s43 offen lds
    s_add_u32 m0, s12, 149504
    s_add_u32 s43, s55, 1792
    buffer_load_dwordx4 v6, s[20:23], s43 offen lds
    s_add_u32 s55, s55, 86016
    s_cmp_ge_u32 s55, 1204224
    s_cselect_b32 s55, 0, s55
    s_add_u32 s24, s54, s52
    s_cmp_ge_u32 s33, 2
    s_cbranch_scc1 Q_XSKIP6
    s_add_u32 m0, s12, 24576
    s_add_u32 s43, s24, 171136
    buffer_load_dwordx4 v5, s[16:19], s43 offen lds
Q_XSKIP6:
    s_waitcnt vmcnt(12)
    s_barrier
    s_add_u32 m0, s12, 0
    s_add_u32 s43, s54, s51
    buffer_load_dwordx4 v5, s[16:19], s43 offen lds
    s_add_u32 m0, s12, 4096
    s_add_u32 s43, s24, 28672
    buffer_load_dwordx4 v5, s[16:19], s43 offen lds
    s_add_u32 m0, s12, 8192
    s_add_u32 s43, s24, 57344
    buffer_load_dwordx4 v5, s[16:19], s43 offen lds
    s_add_u32 m0, s12, 12288
    s_add_u32 s43, s54, s53
    buffer_load_dwordx4 v5, s[16:19], s43 offen lds
    s_add_u32 m0, s12, 16384
    s_add_u32 s43, s24, 113792
    buffer_load_dwordx4 v5, s[16:19], s43 offen lds
    s_add_u32 m0, s12, 20480
    s_add_u32 s43, s24, 142464
    buffer_load_dwordx4 v5, s[16:19], s43 offen lds
    s_add_u32 s54, s54, 128
    s_cmp_ge_u32 s54, 896
    s_cselect_b32 s54, 0, s54
    s_add_u32 m0, s12, 79872
    s_add_u32 s43, s55, 0
    buffer_load_dwordx4 v6, s[20:23], s43 offen lds
    s_waitcnt vmcnt(10)
    s_barrier
    s_add_u32 m0, s12, 83968
    s_add_u32 s43, s55, 896
    buffer_load_dwordx4 v6, s[20:23], s43 offen lds
    s_add_u32 m0, s12, 88064
    s_add_u32 s43, s55, 1792
    buffer_load_dwordx4 v6, s[20:23], s43 offen lds
    s_add_u32 s55, s55, 86016
    s_add_u32 m0, s12, 92160
    s_add_u32 s43, s55, 0
    buffer_load_dwordx4 v6, s[20:23], s43 offen lds
    s_add_u32 m0, s12, 96256
    s_add_u32 s43, s55, 896
    buffer_load_dwordx4 v6, s[20:23], s43 offen lds
    s_add_u32 m0, s12, 100352
    s_add_u32 s43, s55, 1792
    buffer_load_dwordx4 v6, s[20:23], s43 offen lds
    s_add_u32 s55, s55, 86016
    s_cmp_ge_u32 s55, 1204224
    s_cselect_b32 s55, 0, s55
    s_add_u32 m0, s12, 106496
    s_mov_b32 s43, 372736
    buffer_load_dwordx4 v60, s[56:59], s43 offen lds
    s_add_u32 m0, s12, 110592
    s_mov_b32 s43, 430080
    buffer_load_dwordx4 v60, s[56:59], s43 offen lds
    s_add_u32 m0, s12, 114688
    s_mov_b32 s43, 458752
    buffer_load_dwordx4 v60, s[56:59], s43 offen lds
    s_add_u32 m0, s12, 118784
    s_mov_b32 s43, 516096
    buffer_load_dwordx4 v60, s[56:59], s43 offen lds
    s_waitcnt vmcnt(16)
    s_barrier
    buffer_load_dwordx2 v[16:17], v9, s[28:31], 0 offen sc1
    s_add_u32 m0, s12, 122880
    s_mov_b32 s43, 487424
    buffer_load_dwordx4 v60, s[56:59], s43 offen lds
    s_add_u32 m0, s12, 126976
    s_mov_b32 s43, 544768
    buffer_load_dwordx4 v60, s[56:59], s43 offen lds
    s_add_u32 m0, s12, 131072
    s_mov_b32 s43, 573440
    buffer_load_dwordx4 v60, s[56:59], s43 offen lds
    s_add_u32 m0, s12, 135168
    s_mov_b32 s43, 630784
    buffer_load_dwordx4 v60, s[56:59], s43 offen lds
    s_mov_b32 s43, 688128
    buffer_load_dwordx4 v[64:67], v60, s[56:59], s43 offen
    s_mov_b32 s43, 745472
    buffer_load_dwordx4 v[68:71], v60, s[56:59], s43 offen
    s_mov_b32 s43, 716800
    buffer_load_dwordx4 v[72:75], v60, s[56:59], s43 offen
    s_mov_b32 s43, 774144
    buffer_load_dwordx4 v[76:79], v60, s[56:59], s43 offen
    s_mov_b32 s43, 802816
    buffer_load_dwordx4 v[80:83], v60, s[56:59], s43 offen
    s_mov_b32 s43, 860160
    buffer_load_dwordx4 v[84:87], v60, s[56:59], s43 offen
    s_waitcnt vmcnt(18)
    s_barrier
    s_add_u32 m0, s12, 49152
    s_mov_b32 s43, 0
    buffer_load_dwordx4 v60, s[56:59], s43 offen lds
    s_add_u32 m0, s12, 53248
    s_mov_b32 s43, 57344
    buffer_load_dwordx4 v60, s[56:59], s43 offen lds
    s_add_u32 m0, s12, 57344
    s_mov_b32 s43, 28672
    buffer_load_dwordx4 v60, s[56:59], s43 offen lds
    s_add_u32 m0, s12, 61440
    s_mov_b32 s43, 86016
    buffer_load_dwordx4 v60, s[56:59], s43 offen lds
    s_add_u32 m0, s12, 65536
    s_mov_b32 s43, 114688
    buffer_load_dwordx4 v60, s[56:59], s43 offen lds
    s_add_u32 m0, s12, 69632
    s_mov_b32 s43, 172032
    buffer_load_dwordx4 v60, s[56:59], s43 offen lds
    s_add_u32 m0, s12, 139264
    s_mov_b32 s43, 602112
    buffer_load_dwordx4 v60, s[56:59], s43 offen lds
    s_add_u32 m0, s12, 143360
    s_mov_b32 s43, 659456
    buffer_load_dwordx4 v60, s[56:59], s43 offen lds
    s_mov_b32 s43, 831488
    buffer_load_dwordx4 v[88:91], v60, s[56:59], s43 offen
    s_mov_b32 s43, 888832
    buffer_load_dwordx4 v[92:95], v60, s[56:59], s43 offen
    s_waitcnt vmcnt(25)
    s_barrier
    s_mov_b32 s44, 32768
    v_cmp_gt_u32 s[40:41], s44, v9
    s_mov_b32 s44, 0
    s_waitcnt vmcnt(20)
Q_SC_CHK:
    v_cmp_eq_u32 vcc, v63, v17
    s_add_u32 s44, s44, 1
    s_cmp_ge_u32 s44, 60000
    s_cbranch_scc1 Q_SC_OK
    s_andn2_b64 s[42:43], s[40:41], vcc
    s_cbranch_scc0 Q_SC_OK
    buffer_load_dwordx2 v[16:17], v9, s[28:31], 0 offen sc1
    s_waitcnt vmcnt(0)
    s_branch Q_SC_CHK
Q_SC_OK:
    v_and_b32 v17, s32, v16
    v_max_f32 v17, 0x3a83126f, v17
    v_rcp_f32 v17, v17
    v_lshlrev_b32 v16, 16, v16
    ds_write_b64 v8, v[16:17]
    s_add_u32 m0, s12, 73728
    s_mov_b32 s43, 143360
    buffer_load_dwordx4 v60, s[56:59], s43 offen lds
    s_add_u32 m0, s12, 77824
    s_mov_b32 s43, 200704
    buffer_load_dwordx4 v60, s[56:59], s43 offen lds
    s_add_u32 m0, s12, 81920
    s_mov_b32 s43, 229376
    buffer_load_dwordx4 v60, s[56:59], s43 offen lds
    s_add_u32 m0, s12, 86016
    s_mov_b32 s43, 286720
    buffer_load_dwordx4 v60, s[56:59], s43 offen lds
    s_mov_b32 s43, 917504
    buffer_load_dwordx4 v[96:99], v60, s[56:59], s43 offen
    s_mov_b32 s43, 974848
    buffer_load_dwordx4 v[100:103], v60, s[56:59], s43 offen
    s_mov_b32 s43, 946176
    buffer_load_dwordx4 v[104:107], v60, s[56:59], s43 offen
    s_mov_b32 s43, 1003520
    buffer_load_dwordx4 v[108:111], v60, s[56:59], s43 offen
    s_mov_b32 s43, 1032192
    buffer_load_dwordx4 v[112:115], v60, s[56:59], s43 offen
    s_mov_b32 s43, 1089536
    buffer_load_dwordx4 v[116:119], v60, s[56:59], s43 offen
    s_waitcnt lgkmcnt(0)
    s_barrier
    s_cmp_ge_u32 s79, 7
    s_cbranch_scc1 QH_NOTILE
    s_add_u32 m0, s12, 90112
    s_mov_b32 s43, 258048
    buffer_load_dwordx4 v60, s[56:59], s43 offen lds
    s_add_u32 m0, s12, 94208
    s_mov_b32 s43, 315392
    buffer_load_dwordx4 v60, s[56:59], s43 offen lds
    s_add_u32 m0, s12, 98304
    s_mov_b32 s43, 344064
    buffer_load_dwordx4 v60, s[56:59], s43 offen lds
    s_add_u32 m0, s12, 102400
    s_mov_b32 s43, 401408
    buffer_load_dwordx4 v60, s[56:59], s43 offen lds
    s_mov_b32 s43, 1060864
    buffer_load_dwordx4 v[120:123], v60, s[56:59], s43 offen
    s_mov_b32 s43, 1118208
    buffer_load_dwordx4 v[124:127], v60, s[56:59], s43 offen
    s_mov_b32 s43, 1146880
    buffer_load_dwordx4 v[128:131], v60, s[56:59], s43 offen
    s_mov_b32 s43, 1204224
    buffer_load_dwordx4 v[132:135], v60, s[56:59], s43 offen
    s_mov_b32 s43, 1175552
    buffer_load_dwordx4 v[136:139], v60, s[56:59], s43 offen
    s_mov_b32 s43, 1232896
    buffer_load_dwordx4 v[140:143], v60, s[56:59], s43 offen
    s_mov_b32 s43, 1261568
    buffer_load_dwordx4 v[144:147], v60, s[56:59], s43 offen
    s_mov_b32 s43, 1318912
    buffer_load_dwordx4 v[148:151], v60, s[56:59], s43 offen
    s_mov_b32 s43, 1290240
    buffer_load_dwordx4 v[152:155], v60, s[56:59], s43 offen
    s_mov_b32 s43, 1347584
    buffer_load_dwordx4 v[156:159], v60, s[56:59], s43 offen
    s_mov_b32 s43, 1376256
    buffer_load_dwordx4 v[160:163], v60, s[56:59], s43 offen
    s_mov_b32 s43, 1433600
    buffer_load_dwordx4 v[164:167], v60, s[56:59], s43 offen
    s_barrier
    s_lshl_b32 s40, s78, 6
    s_lshl_b32 s41, s33, 4
    s_add_u32 s40, s40, s41
    s_lshl_b32 s42, s79, 7
    v_lshl_add_u32 v31, v4, 4, s42
    v_add_u32 v28, s40, v3
    v_mul_u32_u24 v29, 745, v28
    v_lshrrev_b32 v29, 17, v29
    v_mul_u32_u24 v30, 176, v29
    v_sub_u32 v30, v28, v30
    v_sub_u32 v28, v28, v29
    v_cmp_eq_u32 vcc, 175, v30
    v_mov_b32 v30, 4096
    s_add_u32 s40, s40, 8
    v_cndmask_b32 v28, v28, v30, vcc
    v_lshlrev_b32 v10, 4, v28
    v_mul_u32_u24 v28, 896, v28
    v_add_u32 v8, v28, v31
    v_add_u32 v28, s40, v3
    v_mul_u32_u24 v29, 745, v28
    v_lshrrev_b32 v29, 17, v29
    v_mul_u32_u24 v30, 176, v29
    v_sub_u32 v30, v28, v30
    v_sub_u32 v28, v28, v29
    v_cmp_eq_u32 vcc, 175, v30
    v_mov_b32 v30, 4096
    s_add_u32 s40, s40, 8
    v_cndmask_b32 v28, v28, v30, vcc
    v_lshlrev_b32 v11, 4, v28
    v_mul_u32_u24 v28, 896, v28
    v_add_u32 v9, v28, v31
    v_lshl_add_u32 v12, v0, 4, s12
    s_lshr_b32 s41, s33, 1
    s_mul_i32 s41, s41, 16896
    s_and_b32 s42, s33, 1
    s_lshl_b32 s42, s42, 8
    s_add_u32 s41, s41, s42
    s_add_u32 s41, s41, 16384
    v_mul_u32_u24 v28, 1056, v4
    v_lshl_add_u32 v28, v3, 4, v28
    v_add_u32 v13, s41, v28
    s_mov_b32 s20, s70
    s_mov_b32 s21, s71
    s_mov_b32 s22, 1835008
    s_mov_b32 s23, 0x00020000
    s_mov_b32 s43, 1404928
    buffer_load_dwordx4 v[168:171], v60, s[56:59], s43 offen
    s_mov_b32 s43, 1462272
    buffer_load_dwordx4 v[172:175], v60, s[56:59], s43 offen
    s_mov_b32 s43, 1490944
    buffer_load_dwordx4 v[176:179], v60, s[56:59], s43 offen
    s_mov_b32 s43, 1548288
    buffer_load_dwordx4 v[180:183], v60, s[56:59], s43 offen
    s_mov_b32 s43, 1519616
    buffer_load_dwordx4 v[184:187], v60, s[56:59], s43 offen
    s_mov_b32 s43, 1576960
    buffer_load_dwordx4 v[188:191], v60, s[56:59], s43 offen
    s_mov_b32 s43, 0
    buffer_load_dwordx4 v[192:195], v61, s[60:63], s43 offen
    s_mov_b32 s43, 200704
    buffer_load_dwordx4 v[196:199], v61, s[60:63], s43 offen
    s_mov_b32 s43, 25088
    buffer_load_dwordx4 v[200:203], v61, s[60:63], s43 offen
    s_mov_b32 s43, 225792
    buffer_load_dwordx4 v[204:207], v61, s[60:63], s43 offen
    s_mov_b32 s43, 50176
    buffer_load_dwordx4 v[208:211], v61, s[60:63], s43 offen
    s_mov_b32 s43, 250880
    buffer_load_dwordx4 v[212:215], v61, s[60:63], s43 offen
    s_mov_b32 s43, 75264
    buffer_load_dwordx4 v[216:219], v61, s[60:63], s43 offen
    s_mov_b32 s43, 275968
    buffer_load_dwordx4 v[220:223], v61, s[60:63], s43 offen
    s_mov_b32 s43, 100352
    buffer_load_dwordx4 v[224:227], v61, s[60:63], s43 offen
    s_mov_b32 s43, 301056
    buffer_load_dwordx4 v[228:231], v61, s[60:63], s43 offen
    s_mov_b32 s43, 125440
    buffer_load_dwordx4 v[232:235], v61, s[60:63], s43 offen
    s_mov_b32 s43, 326144
    buffer_load_dwordx4 v[236:239], v61, s[60:63], s43 offen
    s_mov_b32 s43, 150528
    buffer_load_dwordx4 v[240:243], v61, s[60:63], s43 offen
    s_mov_b32 s43, 351232
    buffer_load_dwordx4 v[244:247], v61, s[60:63], s43 offen
    s_mov_b32 s43, 175616
    buffer_load_dwordx4 v[248:251], v61, s[60:63], s43 offen
    s_mov_b32 s43, 376320
    buffer_load_dwordx4 v[252:255], v61, s[60:63], s43 offen
    s_waitcnt vmcnt(60)
    v_add_u32 v14, 147456, v12
    ds_write_b128 v14, v[64:67] offset:0
    ds_write_b128 v14, v[68:71] offset:4096
    ds_write_b128 v14, v[72:75] offset:8192
    ds_write_b128 v14, v[76:79] offset:12288
    s_waitcnt lgkmcnt(0)
    s_waitcnt vmcnt(34)
    s_cmp_lg_u32 s14, 4
    s_cbranch_scc1 Q_PH_MID
    s_lshl_b32 s42, s78, 6
    s_add_u32 s43, s42, 63
    s_mul_i32 s40, s42, 5958
    s_lshr_b32 s40, s40, 20
    s_mul_i32 s41, s43, 5958
    s_lshr_b32 s41, s41, 20
    s_mov_b32 s43, 0x7f007f
    s_cmp_eq_u32 s40, s41
    s_cselect_b32 s42, 0x7f, s43
    s_lshl_b32 s40, s40, 7
    s_add_u32 s40, s40, 0
    v_and_b32 v24, 1, v2
    v_lshlrev_b32 v24, 7, v24
    v_lshl_add_u32 v24, v1, 2, v24
    s_mov_b32 s44, 0
    buffer_load_dword v25, v24, s[64:67], s40 offen sc1
Q_PH_MID:
    s_barrier
    s_barrier
    s_cmp_lg_u32 s14, 5
    s_cbranch_scc1 Q_FSET
    s_mov_b64 exec, 1
    buffer_store_dword v63, v62, s[64:67], s38 offen sc1
    s_mov_b64 exec, -1
Q_FSET:
    s_cmp_lg_u32 s14, 4
    s_cbranch_scc1 Q_PH_DONE
    s_branch Q_PH_CHK
Q_PH_LOOP:
    buffer_load_dword v25, v24, s[64:67], s40 offen sc1
Q_PH_CHK:
    s_add_u32 s44, s44, 1
    s_waitcnt vmcnt(0)
    v_cmp_eq_u32 vcc, v63, v25
    s_cmp_ge_u32 s44, 60000
    s_cbranch_scc1 Q_PH_DONE
    s_nop 1
    s_andn2_b32 s45, s42, vcc_lo
    s_cbranch_scc1 Q_PH_LOOP
Q_PH_DONE:
    s_barrier
    s_branch P2_HELPER_Q
QH_NOTILE:
    s_barrier
    s_barrier
    s_cmp_lg_u32 s14, 4
    s_cbranch_scc1 Q_FSET2
    s_mov_b64 exec, 1
    buffer_store_dword v63, v62, s[64:67], s38 offen sc1
    s_mov_b64 exec, -1
Q_FSET2:
    s_endpgm
Q_COMPUTE:
    s_mov_b32 s34, 0x80008000
    s_mov_b32 s35, 0x80008000
    s_setprio 2
    s_waitcnt lgkmcnt(0)
    s_mov_b32 s36, 0x00010001
    s_mov_b32 s37, 0x00010001
    s_lshr_b32 s51, s33, 1
    s_and_b32 s52, s33, 1
    v_lshrrev_b32 v16, 1, v1
    v_xor_b32 v16, v16, v2
    v_lshlrev_b32 v16, 4, v16
    v_lshl_add_u32 v5, v1, 7, v16
    v_xor_b32 v6, 64, v5
    s_mul_i32 s40, s52, 12288
    s_add_u32 s40, s40, 2048
    v_add_u32 v3, s40, v5
    v_add_u32 v4, s40, v6
    v_bfe_u32 v16, v0, 2, 2
    v_lshl_add_u32 v17, v2, 3, v16
    v_lshlrev_b32 v17, 7, v17
    v_bfe_u32 v18, v0, 3, 2
    v_lshlrev_b32 v18, 5, v18
    v_and_b32 v19, 3, v0
    v_cmp_eq_u32 vcc, 3, v19
    s_mul_i32 s40, s51, 56
    v_lshl_add_u32 v19, v19, 3, s40
    v_xor_b32 v16, v19, v18
    v_add_u32 v20, v16, v17
    v_add_u32 v19, 32, v19
    v_mov_b32 v16, 112
    v_cndmask_b32 v19, v19, v16, vcc
    v_xor_b32 v16, v19, v18
    v_add_u32 v21, v16, v17
    s_cmp_eq_u32 s52, 0
    s_cselect_b64 vcc, -1, 0
    v_cndmask_b32 v7, v21, v20, vcc
    v_cndmask_b32 v8, v20, v21, vcc
    v_mov_b32 v9, 145408
    v_mov_b32 v10, 155648
    v_mov_b32 v16, 0x3f803f80
    v_mov_b32 v17, 0x3f803f80
    ds_write_b64 v10, v[16:17]
    ds_write_b64 v10, v[16:17] offset:8
    v_mov_b64 v[248:249], 0
    v_mov_b64 v[250:251], 0
    v_mov_b64 v[252:253], 0
    v_mov_b64 v[254:255], 0
    s_nop 1
    v_mfma_f32_32x32x16_bf16 v[104:119], v[248:251], v[248:251], 0
    v_mfma_f32_32x32x16_bf16 v[120:135], v[248:251], v[248:251], 0
    v_mfma_f32_32x32x16_bf16 v[136:151], v[248:251], v[248:251], 0
    v_mfma_f32_32x32x16_bf16 v[152:167], v[248:251], v[248:251], 0
    v_mfma_f32_32x32x16_bf16 v[168:183], v[248:251], v[248:251], 0
    v_mfma_f32_32x32x16_bf16 v[184:199], v[248:251], v[248:251], 0
    v_mfma_f32_32x32x16_bf16 v[200:215], v[248:251], v[248:251], 0
    v_mfma_f32_32x32x16_bf16 v[216:231], v[248:251], v[248:251], 0
    v_mfma_f32_32x32x16_bf16 v[232:247], v[248:251], v[248:251], 0
    s_mov_b32 s56, 0xaaaaaaaa
    s_mov_b32 s57, 0xaaaaaaaa
    s_mov_b32 s62, 0x3e41848f
    s_mov_b32 s63, 0x3e41848f
    s_mov_b32 s64, 0x3fb8aa3b
    s_mov_b32 s65, 0x3fb8aa3b
    s_mov_b32 s58, 0xfff0ffff
    s_mov_b32 s59, 0xf000ff00
    s_mov_b32 s60, 0xffc0fffc
    s_mov_b32 s61, 0xc000fc00
    s_mul_i32 s46, s51, 6400
    s_mul_i32 s47, s51, 14976
    s_add_u32 s47, s47, 12800
    s_waitcnt lgkmcnt(0)
    v_mul_u32_u24 v28, 80, v1
    v_lshl_add_u32 v28, v2, 4, v28
    s_mul_i32 s40, s52, 2480
    s_add_u32 s40, s40, s46
    v_add_u32 v22, s40, v28
    s_mul_i32 s40, s52, 2560
    s_add_u32 s40, s40, s46
    s_add_u32 s40, s40, 1280
    v_add_u32 v16, s40, v28
    s_lshl_b32 s40, s52, 3
    s_add_u32 s40, s40, s46
    v_add_u32 v17, s40, v28
    v_mul_u32_u24 v28, 72, v1
    v_lshl_add_u32 v28, v2, 3, v28
    s_mul_i32 s40, s52, 6840
    s_add_u32 s40, s40, s47
    s_lshl_b32 s41, s52, 5
    s_add_u32 s42, s40, 1152
    s_add_u32 s43, s42, s41
    v_add_u32 v18, s43, v28
    s_sub_u32 s43, s42, s41
    s_add_u32 s43, s43, 32
    v_add_u32 v19, s43, v28
    s_add_u32 s42, s47, 9072
    v_lshl_add_u32 v30, v2, 3, s42
    v_cndmask_b32 v20, v18, v30, s[34:35]
    v_add_u32 v30, 32, v30
    v_cndmask_b32 v21, v19, v30, s[34:35]
    v_lshrrev_b32 v30, 2, v0
    v_mul_u32_u24 v30, 72, v30
    v_and_b32 v29, 3, v0
    v_lshl_add_u32 v30, v29, 3, v30
    v_add_u32 v23, s40, v30
    s_lshl_b32 s43, s50, 1
    s_add_u32 s43, s43, s52
    s_mul_i32 s43, s43, 96
    s_lshl_b32 s42, s48, 1
    s_add_u32 s43, s43, s42
    s_add_u32 s43, s43, s51
    s_lshl_b32 s43, s43, 10
    s_add_u32 s43, s43, 7569408
    v_lshl_add_u32 v24, v0, 4, s43
    s_mov_b32 s28, s74
    s_mov_b32 s29, s75
    s_mov_b32 s30, 9732096
    s_mov_b32 s31, 0x00020000
    s_mov_b32 s53, 0
    s_mov_b32 s55, 79872
    s_mov_b32 s66, 0
    s_mov_b32 s54, 0
    v_add_u32 v11, s53, v3
    v_add_u32 v13, s53, v5
    v_cndmask_b32 v12, v11, v9, s[34:35]
    v_cndmask_b32 v13, v13, v10, s[36:37]
    v_add_u32 v14, s55, v7
    v_add_u32 v15, s55, v8
    s_mov_b32 s40, 0x0fffffff
    s_mov_b32 s41, 0x0fffffff
    s_waitcnt vmcnt(0)
    v_lshlrev_b32 v56, 16, v32
    v_and_b32 v57, s32, v32
    v_lshlrev_b32 v58, 16, v33
    v_and_b32 v59, s32, v33
    v_lshlrev_b32 v60, 16, v34
    v_and_b32 v61, s32, v34
    v_lshlrev_b32 v62, 16, v35
    v_and_b32 v63, s32, v35
    v_lshlrev_b32 v64, 16, v36
    v_and_b32 v65, s32, v36
    v_lshlrev_b32 v66, 16, v37
    v_and_b32 v67, s32, v37
    v_lshlrev_b32 v68, 16, v38
    v_and_b32 v69, s32, v38
    v_lshlrev_b32 v70, 16, v39
    v_and_b32 v71, s32, v39
    v_pk_add_f32 v[72:73], v[56:57], v[58:59]
    v_pk_add_f32 v[72:73], v[72:73], v[60:61]
    v_pk_add_f32 v[72:73], v[72:73], v[62:63]
    v_pk_add_f32 v[72:73], v[72:73], v[64:65]
    v_pk_add_f32 v[72:73], v[72:73], v[66:67]
    v_pk_add_f32 v[72:73], v[72:73], v[68:69]
    v_pk_add_f32 v[72:73], v[72:73], v[70:71]
    v_add_f32 v72, v72, v73
    s_nop 1
    v_add_f32_dpp v72, v72, v72 quad_perm:[1,0,3,2] row_mask:0xf bank_mask:0xf
    s_nop 1
    v_add_f32_dpp v72, v72, v72 quad_perm:[2,3,0,1] row_mask:0xf bank_mask:0xf
    s_nop 1
    v_add_f32_dpp v72, v72, v72 row_half_mirror row_mask:0xf bank_mask:0xf
    s_nop 1
    v_add_f32_dpp v72, v72, v72 row_mirror row_mask:0xf bank_mask:0xf
    v_mov_b32 v74, v72
    s_nop 1
    v_permlane16_swap_b32 v72, v74
    v_add_f32 v72, v72, v74
    v_mul_f32 v72, 0xbb124925, v72
    v_pk_add_f32 v[56:57], v[56:57], v[72:73] op_sel:[0,0] op_sel_hi:[1,0]
    v_pk_add_f32 v[58:59], v[58:59], v[72:73] op_sel:[0,0] op_sel_hi:[1,0]
    v_pk_add_f32 v[60:61], v[60:61], v[72:73] op_sel:[0,0] op_sel_hi:[1,0]
    v_pk_add_f32 v[62:63], v[62:63], v[72:73] op_sel:[0,0] op_sel_hi:[1,0]
    v_pk_add_f32 v[64:65], v[64:65], v[72:73] op_sel:[0,0] op_sel_hi:[1,0]
    v_pk_add_f32 v[66:67], v[66:67], v[72:73] op_sel:[0,0] op_sel_hi:[1,0]
    v_pk_add_f32 v[68:69], v[68:69], v[72:73] op_sel:[0,0] op_sel_hi:[1,0]
    v_pk_add_f32 v[70:71], v[70:71], v[72:73] op_sel:[0,0] op_sel_hi:[1,0]
    v_pk_mul_f32 v[74:75], v[56:57], v[56:57]
    v_pk_fma_f32 v[74:75], v[58:59], v[58:59], v[74:75]
    v_pk_fma_f32 v[74:75], v[60:61], v[60:61], v[74:75]
    v_pk_fma_f32 v[74:75], v[62:63], v[62:63], v[74:75]
    v_pk_fma_f32 v[74:75], v[64:65], v[64:65], v[74:75]
    v_pk_fma_f32 v[74:75], v[66:67], v[66:67], v[74:75]
    v_pk_fma_f32 v[74:75], v[68:69], v[68:69], v[74:75]
    v_pk_fma_f32 v[74:75], v[70:71], v[70:71], v[74:75]
    v_add_f32 v73, v74, v75
    v_cndmask_b32 v73, 0, v73, s[40:41]
    s_nop 1
    v_add_f32_dpp v73, v73, v73 quad_perm:[1,0,3,2] row_mask:0xf bank_mask:0xf
    s_nop 1
    v_add_f32_dpp v73, v73, v73 quad_perm:[2,3,0,1] row_mask:0xf bank_mask:0xf
    s_nop 1
    v_add_f32_dpp v73, v73, v73 row_half_mirror row_mask:0xf bank_mask:0xf
    s_nop 1
    v_add_f32_dpp v73, v73, v73 row_mirror row_mask:0xf bank_mask:0xf
    v_mov_b32 v74, v73
    s_nop 1
    v_permlane16_swap_b32 v73, v74
    v_add_f32 v73, v73, v74
    v_mul_f32 v73, 0x3b124925, v73
    v_cvt_pk_bf16_f32 v73, v73, v73
    v_and_b32 v73, 0xffff0000, v73
    v_add_f32 v73, 0x3727c5ac, v73
    v_cvt_pk_bf16_f32 v73, v73, v73
    v_and_b32 v73, 0xffff0000, v73
    v_sqrt_f32 v73, v73
    s_lshl_b32 s40, s33, 3
    s_add_u32 s40, s40, 157968
    v_lshrrev_b32 v74, 5, v0
    v_lshl_add_u32 v74, v74, 2, s40
    v_cvt_pk_bf16_f32 v72, v72, v73
    ds_write_b32 v74, v72
    s_waitcnt lgkmcnt(0)
    s_lshl_b32 s40, s3, 8
    s_lshl_b32 s41, s2, 3
    s_add_u32 s40, s40, s41
    s_add_u32 s40, s40, s14
    s_cmp_lg_u32 s40, 249
    s_cbranch_scc1 Q_NOFL
    s_add_u32 s16, s74, 9764864
    s_addc_u32 s17, s75, 0
    s_mov_b32 s18, 3072
    s_mov_b32 s19, 0x00020000
    s_mov_b32 m0, 157712
    v_lshlrev_b32 v28, 7, v0
    buffer_load_dword v28, s[16:19], 0 offen sc1 lds
Q_NOFL:
    s_barrier
    ds_read_b64_tr_b16 v[56:57], v14 offset:0
    ds_read_b64_tr_b16 v[58:59], v14 offset:512
    ds_read_b64_tr_b16 v[60:61], v15 offset:0
    ds_read_b64_tr_b16 v[62:63], v15 offset:512
    ds_read_b64_tr_b16 v[64:65], v14 offset:4096
    ds_read_b64_tr_b16 v[66:67], v14 offset:4608
    ds_read_b64_tr_b16 v[68:69], v15 offset:4096
    ds_read_b64_tr_b16 v[70:71], v15 offset:4608
    ds_read_b64_tr_b16 v[72:73], v14 offset:8192
    ds_read_b64_tr_b16 v[74:75], v14 offset:8704
    ds_read_b64_tr_b16 v[76:77], v15 offset:8192
    ds_read_b64_tr_b16 v[78:79], v15 offset:8704
    ds_read_b128 v[28:31], v11 offset:0
    ds_read_b128 v[32:35], v11 offset:2048
    ds_read_b128 v[36:39], v11 offset:4096
    ds_read_b128 v[40:43], v11 offset:6144
    ds_read_b128 v[44:47], v11 offset:8192
    ds_read_b128 v[48:51], v12 offset:10240
    ds_read_b128 v[52:55], v13
    s_waitcnt lgkmcnt(0)
Q_LOOP:
    s_waitcnt lgkmcnt(2)
    v_mfma_f32_16x16x32_bf16 v[104:107], v[56:59], v[28:31], v[104:107]
    v_add_u32 v11, s53, v4
    v_add_u32 v13, s53, v6
    v_mfma_f32_16x16x32_bf16 v[108:111], v[60:63], v[28:31], v[108:111]
    v_cndmask_b32 v12, v11, v9, s[34:35]
    v_cndmask_b32 v13, v13, v10, s[36:37]
    v_mfma_f32_16x16x32_bf16 v[112:115], v[64:67], v[28:31], v[112:115]
    v_mfma_f32_16x16x32_bf16 v[116:119], v[68:71], v[28:31], v[116:119]
    v_mfma_f32_16x16x32_bf16 v[120:123], v[72:75], v[28:31], v[120:123]
    v_mfma_f32_16x16x32_bf16 v[124:127], v[76:79], v[28:31], v[124:127]
    s_waitcnt lgkmcnt(0)
    s_barrier
    ds_read_b128 v[28:31], v11 offset:0
    v_mfma_f32_16x16x32_bf16 v[248:251], v[64:67], v[52:55], v[248:251]
    s_add_u32 s55, s55, 12288
    s_cmp_ge_u32 s55, 153600
    s_cselect_b32 s55, 79872, s55
    v_mfma_f32_16x16x32_bf16 v[252:255], v[72:75], v[52:55], v[252:255]
    v_add_u32 v14, s55, v7
    v_add_u32 v15, s55, v8
    ds_read_b128 v[52:55], v13
    v_mfma_f32_16x16x32_bf16 v[128:131], v[56:59], v[32:35], v[128:131]
    ds_read_b64_tr_b16 v[80:81], v14 offset:0
    v_mfma_f32_16x16x32_bf16 v[132:135], v[60:63], v[32:35], v[132:135]
    v_mfma_f32_16x16x32_bf16 v[136:139], v[64:67], v[32:35], v[136:139]
    ds_read_b64_tr_b16 v[82:83], v14 offset:512
    v_mfma_f32_16x16x32_bf16 v[140:143], v[68:71], v[32:35], v[140:143]
    v_mfma_f32_16x16x32_bf16 v[144:147], v[72:75], v[32:35], v[144:147]
    ds_read_b64_tr_b16 v[84:85], v15 offset:0
    v_mfma_f32_16x16x32_bf16 v[148:151], v[76:79], v[32:35], v[148:151]
    ds_read_b128 v[32:35], v11 offset:2048
    v_mfma_f32_16x16x32_bf16 v[152:155], v[56:59], v[36:39], v[152:155]
    ds_read_b64_tr_b16 v[86:87], v15 offset:512
    v_mfma_f32_16x16x32_bf16 v[156:159], v[60:63], v[36:39], v[156:159]
    v_mfma_f32_16x16x32_bf16 v[160:163], v[64:67], v[36:39], v[160:163]
    ds_read_b64_tr_b16 v[88:89], v14 offset:4096
    v_mfma_f32_16x16x32_bf16 v[164:167], v[68:71], v[36:39], v[164:167]
    v_mfma_f32_16x16x32_bf16 v[168:171], v[72:75], v[36:39], v[168:171]
    ds_read_b64_tr_b16 v[90:91], v14 offset:4608
    v_mfma_f32_16x16x32_bf16 v[172:175], v[76:79], v[36:39], v[172:175]
    ds_read_b128 v[36:39], v11 offset:4096
    v_mfma_f32_16x16x32_bf16 v[176:179], v[56:59], v[40:43], v[176:179]
    ds_read_b64_tr_b16 v[92:93], v15 offset:4096
    v_mfma_f32_16x16x32_bf16 v[180:183], v[60:63], v[40:43], v[180:183]
    v_mfma_f32_16x16x32_bf16 v[184:187], v[64:67], v[40:43], v[184:187]
    ds_read_b64_tr_b16 v[94:95], v15 offset:4608
    v_mfma_f32_16x16x32_bf16 v[188:191], v[68:71], v[40:43], v[188:191]
    v_mfma_f32_16x16x32_bf16 v[192:195], v[72:75], v[40:43], v[192:195]
    ds_read_b64_tr_b16 v[96:97], v14 offset:8192
    v_mfma_f32_16x16x32_bf16 v[196:199], v[76:79], v[40:43], v[196:199]
    ds_read_b128 v[40:43], v11 offset:6144
    v_mfma_f32_16x16x32_bf16 v[200:203], v[56:59], v[44:47], v[200:203]
    ds_read_b64_tr_b16 v[98:99], v14 offset:8704
    v_mfma_f32_16x16x32_bf16 v[204:207], v[60:63], v[44:47], v[204:207]
    v_mfma_f32_16x16x32_bf16 v[208:211], v[64:67], v[44:47], v[208:211]
    ds_read_b64_tr_b16 v[100:101], v15 offset:8192
    v_mfma_f32_16x16x32_bf16 v[212:215], v[68:71], v[44:47], v[212:215]
    v_mfma_f32_16x16x32_bf16 v[216:219], v[72:75], v[44:47], v[216:219]
    ds_read_b64_tr_b16 v[102:103], v15 offset:8704
    v_mfma_f32_16x16x32_bf16 v[220:223], v[76:79], v[44:47], v[220:223]
    ds_read_b128 v[44:47], v11 offset:8192
    v_mfma_f32_16x16x32_bf16 v[224:227], v[56:59], v[48:51], v[224:227]
    s_add_u32 s54, s54, 1
    s_cmp_eq_u32 s54, 7
    v_mfma_f32_16x16x32_bf16 v[228:231], v[60:63], v[48:51], v[228:231]
    v_mfma_f32_16x16x32_bf16 v[232:235], v[64:67], v[48:51], v[232:235]
    v_mfma_f32_16x16x32_bf16 v[236:239], v[68:71], v[48:51], v[236:239]
    v_mfma_f32_16x16x32_bf16 v[240:243], v[72:75], v[48:51], v[240:243]
    v_mfma_f32_16x16x32_bf16 v[244:247], v[76:79], v[48:51], v[244:247]
    ds_read_b128 v[48:51], v12 offset:10240
    s_cbranch_scc1 Q_LAST
    s_waitcnt lgkmcnt(2)
    v_mfma_f32_16x16x32_bf16 v[104:107], v[80:83], v[28:31], v[104:107]
    s_add_u32 s53, s53, 26624
    s_cmp_ge_u32 s53, 79872
    v_mfma_f32_16x16x32_bf16 v[108:111], v[84:87], v[28:31], v[108:111]
    s_cselect_b32 s53, 0, s53
    v_add_u32 v11, s53, v3
    v_mfma_f32_16x16x32_bf16 v[112:115], v[88:91], v[28:31], v[112:115]
    v_add_u32 v13, s53, v5
    v_cndmask_b32 v12, v11, v9, s[34:35]
    v_mfma_f32_16x16x32_bf16 v[116:119], v[92:95], v[28:31], v[116:119]
    v_cndmask_b32 v13, v13, v10, s[36:37]
    v_mfma_f32_16x16x32_bf16 v[120:123], v[96:99], v[28:31], v[120:123]
    v_mfma_f32_16x16x32_bf16 v[124:127], v[100:103], v[28:31], v[124:127]
    s_waitcnt lgkmcnt(0)
    s_barrier
    ds_read_b128 v[28:31], v11 offset:0
    v_mfma_f32_16x16x32_bf16 v[248:251], v[88:91], v[52:55], v[248:251]
    s_add_u32 s55, s55, 12288
    s_cmp_ge_u32 s55, 153600
    s_cselect_b32 s55, 79872, s55
    v_mfma_f32_16x16x32_bf16 v[252:255], v[96:99], v[52:55], v[252:255]
    v_add_u32 v14, s55, v7
    v_add_u32 v15, s55, v8
    ds_read_b128 v[52:55], v13
    v_mfma_f32_16x16x32_bf16 v[128:131], v[80:83], v[32:35], v[128:131]
    ds_read_b64_tr_b16 v[56:57], v14 offset:0
    v_mfma_f32_16x16x32_bf16 v[132:135], v[84:87], v[32:35], v[132:135]
    v_mfma_f32_16x16x32_bf16 v[136:139], v[88:91], v[32:35], v[136:139]
    ds_read_b64_tr_b16 v[58:59], v14 offset:512
    v_mfma_f32_16x16x32_bf16 v[140:143], v[92:95], v[32:35], v[140:143]
    v_mfma_f32_16x16x32_bf16 v[144:147], v[96:99], v[32:35], v[144:147]
    ds_read_b64_tr_b16 v[60:61], v15 offset:0
    v_mfma_f32_16x16x32_bf16 v[148:151], v[100:103], v[32:35], v[148:151]
    ds_read_b128 v[32:35], v11 offset:2048
    v_mfma_f32_16x16x32_bf16 v[152:155], v[80:83], v[36:39], v[152:155]
    ds_read_b64_tr_b16 v[62:63], v15 offset:512
    v_mfma_f32_16x16x32_bf16 v[156:159], v[84:87], v[36:39], v[156:159]
    v_mfma_f32_16x16x32_bf16 v[160:163], v[88:91], v[36:39], v[160:163]
    ds_read_b64_tr_b16 v[64:65], v14 offset:4096
    v_mfma_f32_16x16x32_bf16 v[164:167], v[92:95], v[36:39], v[164:167]
    v_mfma_f32_16x16x32_bf16 v[168:171], v[96:99], v[36:39], v[168:171]
    ds_read_b64_tr_b16 v[66:67], v14 offset:4608
    v_mfma_f32_16x16x32_bf16 v[172:175], v[100:103], v[36:39], v[172:175]
    ds_read_b128 v[36:39], v11 offset:4096
    v_mfma_f32_16x16x32_bf16 v[176:179], v[80:83], v[40:43], v[176:179]
    ds_read_b64_tr_b16 v[68:69], v15 offset:4096
    v_mfma_f32_16x16x32_bf16 v[180:183], v[84:87], v[40:43], v[180:183]
    v_mfma_f32_16x16x32_bf16 v[184:187], v[88:91], v[40:43], v[184:187]
    ds_read_b64_tr_b16 v[70:71], v15 offset:4608
    v_mfma_f32_16x16x32_bf16 v[188:191], v[92:95], v[40:43], v[188:191]
    v_mfma_f32_16x16x32_bf16 v[192:195], v[96:99], v[40:43], v[192:195]
    ds_read_b64_tr_b16 v[72:73], v14 offset:8192
    v_mfma_f32_16x16x32_bf16 v[196:199], v[100:103], v[40:43], v[196:199]
    ds_read_b128 v[40:43], v11 offset:6144
    v_mfma_f32_16x16x32_bf16 v[200:203], v[80:83], v[44:47], v[200:203]
    ds_read_b64_tr_b16 v[74:75], v14 offset:8704
    v_mfma_f32_16x16x32_bf16 v[204:207], v[84:87], v[44:47], v[204:207]
    v_mfma_f32_16x16x32_bf16 v[208:211], v[88:91], v[44:47], v[208:211]
    ds_read_b64_tr_b16 v[76:77], v15 offset:8192
    v_mfma_f32_16x16x32_bf16 v[212:215], v[92:95], v[44:47], v[212:215]
    v_mfma_f32_16x16x32_bf16 v[216:219], v[96:99], v[44:47], v[216:219]
    ds_read_b64_tr_b16 v[78:79], v15 offset:8704
    v_mfma_f32_16x16x32_bf16 v[220:223], v[100:103], v[44:47], v[220:223]
    ds_read_b128 v[44:47], v11 offset:8192
    v_mfma_f32_16x16x32_bf16 v[224:227], v[80:83], v[48:51], v[224:227]
    v_mfma_f32_16x16x32_bf16 v[228:231], v[84:87], v[48:51], v[228:231]
    v_mfma_f32_16x16x32_bf16 v[232:235], v[88:91], v[48:51], v[232:235]
    v_mfma_f32_16x16x32_bf16 v[236:239], v[92:95], v[48:51], v[236:239]
    v_mfma_f32_16x16x32_bf16 v[240:243], v[96:99], v[48:51], v[240:243]
    v_mfma_f32_16x16x32_bf16 v[244:247], v[100:103], v[48:51], v[244:247]
    ds_read_b128 v[48:51], v12 offset:10240
    s_branch Q_LOOP
Q_LAST:
    s_waitcnt lgkmcnt(2)
    v_mfma_f32_16x16x32_bf16 v[248:251], v[88:91], v[52:55], v[248:251]
    v_lshlrev_b32 v11, 3, v1
    v_add_u32 v11, 153600, v11
    v_mfma_f32_16x16x32_bf16 v[252:255], v[96:99], v[52:55], v[252:255]
    s_mul_i32 s40, s52, 768
    v_add_u32 v12, s40, v11
    v_mfma_f32_16x16x32_bf16 v[120:123], v[96:99], v[28:31], v[120:123]
    s_mul_i32 s40, s52, 6840
    s_add_u32 s40, s40, 1152
    v_mfma_f32_16x16x32_bf16 v[124:127], v[100:103], v[28:31], v[124:127]
    v_subrev_u32 v13, s40, v18
    v_mfma_f32_16x16x32_bf16 v[144:147], v[96:99], v[32:35], v[144:147]
    v_mfma_f32_16x16x32_bf16 v[148:151], v[100:103], v[32:35], v[148:151]
    s_waitcnt lgkmcnt(0)
    s_barrier
    v_mfma_f32_16x16x32_bf16 v[240:243], v[96:99], v[48:51], v[240:243]
    ds_read_b64 v[68:69], v11
    ds_read_b64 v[56:57], v12 offset:128
    ds_read_b64 v[58:59], v12 offset:256
    v_mfma_f32_16x16x32_bf16 v[244:247], v[100:103], v[48:51], v[244:247]
    ds_read_b64 v[60:61], v12 offset:384
    ds_read_b64 v[62:63], v12 offset:512
    ds_read_b64 v[64:65], v12 offset:640
    v_mfma_f32_16x16x32_bf16 v[168:171], v[96:99], v[36:39], v[168:171]
    ds_read_b64 v[66:67], v12 offset:768
    v_mov_b32_dpp v72, v248 row_newbcast:0 row_mask:0xf bank_mask:0xf
    v_mov_b32_dpp v73, v249 row_newbcast:0 row_mask:0xf bank_mask:0xf
    v_mfma_f32_16x16x32_bf16 v[172:175], v[100:103], v[36:39], v[172:175]
    v_mov_b32_dpp v74, v250 row_newbcast:0 row_mask:0xf bank_mask:0xf
    v_mov_b32_dpp v75, v251 row_newbcast:0 row_mask:0xf bank_mask:0xf
    v_mov_b32_dpp v76, v252 row_newbcast:0 row_mask:0xf bank_mask:0xf
    v_mfma_f32_16x16x32_bf16 v[192:195], v[96:99], v[40:43], v[192:195]
    v_mov_b32_dpp v77, v253 row_newbcast:0 row_mask:0xf bank_mask:0xf
    v_mov_b32_dpp v78, v254 row_newbcast:0 row_mask:0xf bank_mask:0xf
    v_mov_b32_dpp v79, v255 row_newbcast:0 row_mask:0xf bank_mask:0xf
    v_mfma_f32_16x16x32_bf16 v[196:199], v[100:103], v[40:43], v[196:199]
    s_waitcnt lgkmcnt(0)
    v_fmac_f32 v248, v72, v68
    v_fmac_f32 v249, v73, v68
    v_mfma_f32_16x16x32_bf16 v[216:219], v[96:99], v[44:47], v[216:219]
    v_fmac_f32 v250, v74, v68
    v_fmac_f32 v251, v75, v68
    v_fmac_f32 v252, v76, v68
    v_mfma_f32_16x16x32_bf16 v[220:223], v[100:103], v[44:47], v[220:223]
    v_fmac_f32 v253, v77, v68
    v_fmac_f32 v254, v78, v68
    v_fmac_f32 v255, v79, v68
    v_mfma_f32_16x16x32_bf16 v[232:235], v[88:91], v[48:51], v[232:235]
    v_mul_f32 v248, v248, v69
    v_mul_f32 v249, v249, v69
    v_mul_f32 v250, v250, v69
    v_mfma_f32_16x16x32_bf16 v[236:239], v[92:95], v[48:51], v[236:239]
    v_mul_f32 v251, v251, v69
    v_mul_f32 v252, v252, v69
    v_mul_f32 v253, v253, v69
    v_mfma_f32_16x16x32_bf16 v[208:211], v[88:91], v[44:47], v[208:211]
    v_mul_f32 v254, v254, v69
    v_mul_f32 v255, v255, v69
    v_cvt_pk_bf16_f32 v248, v248, v249
    v_mfma_f32_16x16x32_bf16 v[212:215], v[92:95], v[44:47], v[212:215]
    v_cvt_pk_bf16_f32 v249, v250, v251
    v_cvt_pk_bf16_f32 v250, v252, v253
    v_cvt_pk_bf16_f32 v251, v254, v255
    v_mfma_f32_16x16x32_bf16 v[112:115], v[88:91], v[28:31], v[112:115]
    ds_write_b64 v17, v[248:249]
    ds_write_b64 v13, v[250:251]
    v_mov_b32_dpp v72, v240 row_newbcast:15 row_mask:0xf bank_mask:0xf
    v_mfma_f32_16x16x32_bf16 v[116:119], v[92:95], v[28:31], v[116:119]
    v_mov_b32_dpp v73, v241 row_newbcast:15 row_mask:0xf bank_mask:0xf
    v_mov_b32_dpp v74, v242 row_newbcast:15 row_mask:0xf bank_mask:0xf
    v_mov_b32_dpp v75, v243 row_newbcast:15 row_mask:0xf bank_mask:0xf
    v_mfma_f32_16x16x32_bf16 v[136:139], v[88:91], v[32:35], v[136:139]
    v_mov_b32_dpp v76, v244 row_newbcast:15 row_mask:0xf bank_mask:0xf
    v_mov_b32_dpp v77, v245 row_newbcast:15 row_mask:0xf bank_mask:0xf
    v_mov_b32_dpp v78, v246 row_newbcast:15 row_mask:0xf bank_mask:0xf
    v_mfma_f32_16x16x32_bf16 v[140:143], v[92:95], v[32:35], v[140:143]
    v_mov_b32_dpp v79, v247 row_newbcast:15 row_mask:0xf bank_mask:0xf
    v_fmac_f32 v120, v72, v56
    v_fmac_f32 v121, v73, v56
    v_mfma_f32_16x16x32_bf16 v[160:163], v[88:91], v[36:39], v[160:163]
    v_fmac_f32 v122, v74, v56
    v_fmac_f32 v123, v75, v56
    v_fmac_f32 v124, v76, v56
    v_mfma_f32_16x16x32_bf16 v[164:167], v[92:95], v[36:39], v[164:167]
    v_fmac_f32 v125, v77, v56
    v_fmac_f32 v126, v78, v56
    v_fmac_f32 v127, v79, v56
    v_mfma_f32_16x16x32_bf16 v[184:187], v[88:91], v[40:43], v[184:187]
    v_mul_f32 v120, v120, v57
    v_mul_f32 v121, v121, v57
    v_mul_f32 v122, v122, v57
    v_mfma_f32_16x16x32_bf16 v[188:191], v[92:95], v[40:43], v[188:191]
    v_mul_f32 v123, v123, v57
    v_mul_f32 v124, v124, v57
    v_mul_f32 v125, v125, v57
    v_mfma_f32_16x16x32_bf16 v[224:227], v[80:83], v[48:51], v[224:227]
    v_mul_f32 v126, v126, v57
    v_mul_f32 v127, v127, v57
    v_cvt_pk_bf16_f32 v120, v120, v121
    v_mfma_f32_16x16x32_bf16 v[228:231], v[84:87], v[48:51], v[228:231]
    v_cvt_pk_bf16_f32 v121, v122, v123
    v_cvt_pk_bf16_f32 v122, v124, v125
    v_cvt_pk_bf16_f32 v123, v126, v127
    v_mfma_f32_16x16x32_bf16 v[104:107], v[80:83], v[28:31], v[104:107]
    ds_write_b64 v18, v[120:121] offset:0
    ds_write_b64 v19, v[122:123] offset:0
    v_fmac_f32 v144, v72, v58
    v_mfma_f32_16x16x32_bf16 v[108:111], v[84:87], v[28:31], v[108:111]
    v_fmac_f32 v145, v73, v58
    v_fmac_f32 v146, v74, v58
    v_fmac_f32 v147, v75, v58
    v_mfma_f32_16x16x32_bf16 v[128:131], v[80:83], v[32:35], v[128:131]
    v_fmac_f32 v148, v76, v58
    v_fmac_f32 v149, v77, v58
    v_fmac_f32 v150, v78, v58
    v_mfma_f32_16x16x32_bf16 v[132:135], v[84:87], v[32:35], v[132:135]
    v_fmac_f32 v151, v79, v58
    v_mul_f32 v144, v144, v59
    v_mul_f32 v145, v145, v59
    v_mfma_f32_16x16x32_bf16 v[152:155], v[80:83], v[36:39], v[152:155]
    v_mul_f32 v146, v146, v59
    v_mul_f32 v147, v147, v59
    v_mul_f32 v148, v148, v59
    v_mfma_f32_16x16x32_bf16 v[156:159], v[84:87], v[36:39], v[156:159]
    v_mul_f32 v149, v149, v59
    v_mul_f32 v150, v150, v59
    v_mul_f32 v151, v151, v59
    v_mfma_f32_16x16x32_bf16 v[176:179], v[80:83], v[40:43], v[176:179]
    v_cvt_pk_bf16_f32 v144, v144, v145
    v_cvt_pk_bf16_f32 v145, v146, v147
    v_cvt_pk_bf16_f32 v146, v148, v149
    v_mfma_f32_16x16x32_bf16 v[180:183], v[84:87], v[40:43], v[180:183]
    v_cvt_pk_bf16_f32 v147, v150, v151
    ds_write_b64 v18, v[144:145] offset:1152
    ds_write_b64 v19, v[146:147] offset:1152
    v_mfma_f32_16x16x32_bf16 v[200:203], v[80:83], v[44:47], v[200:203]
    v_fmac_f32 v168, v72, v60
    v_fmac_f32 v169, v73, v60
    v_fmac_f32 v170, v74, v60
    v_mfma_f32_16x16x32_bf16 v[204:207], v[84:87], v[44:47], v[204:207]
    v_fmac_f32 v171, v75, v60
    v_fmac_f32 v172, v76, v60
    v_fmac_f32 v173, v77, v60
    v_fmac_f32 v174, v78, v60
    v_fmac_f32 v175, v79, v60
    v_mul_f32 v168, v168, v61
    v_mul_f32 v169, v169, v61
    v_mul_f32 v170, v170, v61
    v_mul_f32 v171, v171, v61
    v_mul_f32 v172, v172, v61
    v_mul_f32 v173, v173, v61
    v_mul_f32 v174, v174, v61
    v_mul_f32 v175, v175, v61
    v_cvt_pk_bf16_f32 v168, v168, v169
    v_cvt_pk_bf16_f32 v169, v170, v171
    v_cvt_pk_bf16_f32 v170, v172, v173
    v_cvt_pk_bf16_f32 v171, v174, v175
    ds_write_b64 v18, v[168:169] offset:2304
    ds_write_b64 v19, v[170:171] offset:2304
    v_pk_fma_f32 v[192:193], v[72:73], v[62:63], v[192:193] op_sel:[0,0,0] op_sel_hi:[1,0,1]
    v_pk_fma_f32 v[194:195], v[74:75], v[62:63], v[194:195] op_sel:[0,0,0] op_sel_hi:[1,0,1]
    v_pk_fma_f32 v[196:197], v[76:77], v[62:63], v[196:197] op_sel:[0,0,0] op_sel_hi:[1,0,1]
    v_pk_fma_f32 v[198:199], v[78:79], v[62:63], v[198:199] op_sel:[0,0,0] op_sel_hi:[1,0,1]
    v_pk_mul_f32 v[192:193], v[192:193], v[62:63] op_sel:[0,1] op_sel_hi:[1,1]
    v_pk_mul_f32 v[194:195], v[194:195], v[62:63] op_sel:[0,1] op_sel_hi:[1,1]
    v_pk_mul_f32 v[196:197], v[196:197], v[62:63] op_sel:[0,1] op_sel_hi:[1,1]
    v_pk_mul_f32 v[198:199], v[198:199], v[62:63] op_sel:[0,1] op_sel_hi:[1,1]
    v_cvt_pk_bf16_f32 v192, v192, v193
    v_cvt_pk_bf16_f32 v193, v194, v195
    v_cvt_pk_bf16_f32 v194, v196, v197
    v_cvt_pk_bf16_f32 v195, v198, v199
    ds_write_b64 v18, v[192:193] offset:3456
    ds_write_b64 v19, v[194:195] offset:3456
    v_pk_fma_f32 v[216:217], v[72:73], v[64:65], v[216:217] op_sel:[0,0,0] op_sel_hi:[1,0,1]
    v_pk_fma_f32 v[218:219], v[74:75], v[64:65], v[218:219] op_sel:[0,0,0] op_sel_hi:[1,0,1]
    v_pk_fma_f32 v[220:221], v[76:77], v[64:65], v[220:221] op_sel:[0,0,0] op_sel_hi:[1,0,1]
    v_pk_fma_f32 v[222:223], v[78:79], v[64:65], v[222:223] op_sel:[0,0,0] op_sel_hi:[1,0,1]
    v_pk_mul_f32 v[216:217], v[216:217], v[64:65] op_sel:[0,1] op_sel_hi:[1,1]
    v_pk_mul_f32 v[218:219], v[218:219], v[64:65] op_sel:[0,1] op_sel_hi:[1,1]
    v_pk_mul_f32 v[220:221], v[220:221], v[64:65] op_sel:[0,1] op_sel_hi:[1,1]
    v_pk_mul_f32 v[222:223], v[222:223], v[64:65] op_sel:[0,1] op_sel_hi:[1,1]
    v_cvt_pk_bf16_f32 v216, v216, v217
    v_cvt_pk_bf16_f32 v217, v218, v219
    v_cvt_pk_bf16_f32 v218, v220, v221
    v_cvt_pk_bf16_f32 v219, v222, v223
    ds_write_b64 v18, v[216:217] offset:4608
    ds_write_b64 v19, v[218:219] offset:4608
    v_pk_fma_f32 v[240:241], v[72:73], v[66:67], v[240:241] op_sel:[0,0,0] op_sel_hi:[1,0,1]
    v_pk_fma_f32 v[242:243], v[74:75], v[66:67], v[242:243] op_sel:[0,0,0] op_sel_hi:[1,0,1]
    v_pk_fma_f32 v[244:245], v[76:77], v[66:67], v[244:245] op_sel:[0,0,0] op_sel_hi:[1,0,1]
    v_pk_fma_f32 v[246:247], v[78:79], v[66:67], v[246:247] op_sel:[0,0,0] op_sel_hi:[1,0,1]
    v_pk_mul_f32 v[240:241], v[240:241], v[66:67] op_sel:[0,1] op_sel_hi:[1,1]
    v_pk_mul_f32 v[242:243], v[242:243], v[66:67] op_sel:[0,1] op_sel_hi:[1,1]
    v_pk_mul_f32 v[244:245], v[244:245], v[66:67] op_sel:[0,1] op_sel_hi:[1,1]
    v_pk_mul_f32 v[246:247], v[246:247], v[66:67] op_sel:[0,1] op_sel_hi:[1,1]
    v_cvt_pk_bf16_f32 v240, v240, v241
    v_cvt_pk_bf16_f32 v241, v242, v243
    v_cvt_pk_bf16_f32 v242, v244, v245
    v_cvt_pk_bf16_f32 v243, v246, v247
    ds_write_b64 v20, v[240:241] offset:5760
    ds_write_b64 v21, v[242:243] offset:5760
    v_mov_b32_dpp v72, v232 row_newbcast:15 row_mask:0xf bank_mask:0xf
    v_mov_b32_dpp v73, v233 row_newbcast:15 row_mask:0xf bank_mask:0xf
    v_mov_b32_dpp v74, v234 row_newbcast:15 row_mask:0xf bank_mask:0xf
    v_mov_b32_dpp v75, v235 row_newbcast:15 row_mask:0xf bank_mask:0xf
    v_mov_b32_dpp v76, v236 row_newbcast:15 row_mask:0xf bank_mask:0xf
    v_mov_b32_dpp v77, v237 row_newbcast:15 row_mask:0xf bank_mask:0xf
    v_mov_b32_dpp v78, v238 row_newbcast:15 row_mask:0xf bank_mask:0xf
    v_mov_b32_dpp v79, v239 row_newbcast:15 row_mask:0xf bank_mask:0xf
    v_pk_fma_f32 v[208:209], v[72:73], v[64:65], v[208:209] op_sel:[0,0,0] op_sel_hi:[1,0,1]
    v_pk_fma_f32 v[210:211], v[74:75], v[64:65], v[210:211] op_sel:[0,0,0] op_sel_hi:[1,0,1]
    v_pk_fma_f32 v[212:213], v[76:77], v[64:65], v[212:213] op_sel:[0,0,0] op_sel_hi:[1,0,1]
    v_pk_fma_f32 v[214:215], v[78:79], v[64:65], v[214:215] op_sel:[0,0,0] op_sel_hi:[1,0,1]
    v_pk_mul_f32 v[208:209], v[208:209], v[64:65] op_sel:[0,1] op_sel_hi:[1,1]
    v_pk_mul_f32 v[210:211], v[210:211], v[64:65] op_sel:[0,1] op_sel_hi:[1,1]
    v_pk_mul_f32 v[212:213], v[212:213], v[64:65] op_sel:[0,1] op_sel_hi:[1,1]
    v_pk_mul_f32 v[214:215], v[214:215], v[64:65] op_sel:[0,1] op_sel_hi:[1,1]
    v_cvt_pk_bf16_f32 v48, v208, v209
    v_cvt_pk_bf16_f32 v49, v210, v211
    v_cvt_pk_bf16_f32 v50, v212, v213
    v_cvt_pk_bf16_f32 v51, v214, v215
    ds_write2_b64 v16, v[48:49], v[50:51] offset0:1 offset1:0
    v_pk_fma_f32 v[232:233], v[72:73], v[66:67], v[232:233] op_sel:[0,0,0] op_sel_hi:[1,0,1]
    v_pk_fma_f32 v[234:235], v[74:75], v[66:67], v[234:235] op_sel:[0,0,0] op_sel_hi:[1,0,1]
    v_pk_fma_f32 v[236:237], v[76:77], v[66:67], v[236:237] op_sel:[0,0,0] op_sel_hi:[1,0,1]
    v_pk_fma_f32 v[238:239], v[78:79], v[66:67], v[238:239] op_sel:[0,0,0] op_sel_hi:[1,0,1]
    v_pk_mul_f32 v[232:233], v[232:233], v[66:67] op_sel:[0,1] op_sel_hi:[1,1]
    v_pk_mul_f32 v[234:235], v[234:235], v[66:67] op_sel:[0,1] op_sel_hi:[1,1]
    v_pk_mul_f32 v[236:237], v[236:237], v[66:67] op_sel:[0,1] op_sel_hi:[1,1]
    v_pk_mul_f32 v[238:239], v[238:239], v[66:67] op_sel:[0,1] op_sel_hi:[1,1]
    v_cvt_pk_bf16_f32 v52, v232, v233
    v_cvt_pk_bf16_f32 v53, v234, v235
    v_cvt_pk_bf16_f32 v54, v236, v237
    v_cvt_pk_bf16_f32 v55, v238, v239
    ds_write2_b64 v16, v[52:53], v[54:55] offset0:161 offset1:160
    v_pk_fma_f32 v[112:113], v[72:73], v[56:57], v[112:113] op_sel:[0,0,0] op_sel_hi:[1,0,1]
    v_pk_fma_f32 v[114:115], v[74:75], v[56:57], v[114:115] op_sel:[0,0,0] op_sel_hi:[1,0,1]
    v_pk_fma_f32 v[116:117], v[76:77], v[56:57], v[116:117] op_sel:[0,0,0] op_sel_hi:[1,0,1]
    v_pk_fma_f32 v[118:119], v[78:79], v[56:57], v[118:119] op_sel:[0,0,0] op_sel_hi:[1,0,1]
    v_pk_mul_f32 v[112:113], v[112:113], v[56:57] op_sel:[0,1] op_sel_hi:[1,1]
    v_pk_mul_f32 v[114:115], v[114:115], v[56:57] op_sel:[0,1] op_sel_hi:[1,1]
    v_pk_mul_f32 v[116:117], v[116:117], v[56:57] op_sel:[0,1] op_sel_hi:[1,1]
    v_pk_mul_f32 v[118:119], v[118:119], v[56:57] op_sel:[0,1] op_sel_hi:[1,1]
    v_cvt_pk_bf16_f32 v32, v112, v113
    v_cvt_pk_bf16_f32 v33, v114, v115
    v_cvt_pk_bf16_f32 v34, v116, v117
    v_cvt_pk_bf16_f32 v35, v118, v119
    v_pk_fma_f32 v[136:137], v[72:73], v[58:59], v[136:137] op_sel:[0,0,0] op_sel_hi:[1,0,1]
    v_pk_fma_f32 v[138:139], v[74:75], v[58:59], v[138:139] op_sel:[0,0,0] op_sel_hi:[1,0,1]
    v_pk_fma_f32 v[140:141], v[76:77], v[58:59], v[140:141] op_sel:[0,0,0] op_sel_hi:[1,0,1]
    v_pk_fma_f32 v[142:143], v[78:79], v[58:59], v[142:143] op_sel:[0,0,0] op_sel_hi:[1,0,1]
    v_pk_mul_f32 v[136:137], v[136:137], v[58:59] op_sel:[0,1] op_sel_hi:[1,1]
    v_pk_mul_f32 v[138:139], v[138:139], v[58:59] op_sel:[0,1] op_sel_hi:[1,1]
    v_pk_mul_f32 v[140:141], v[140:141], v[58:59] op_sel:[0,1] op_sel_hi:[1,1]
    v_pk_mul_f32 v[142:143], v[142:143], v[58:59] op_sel:[0,1] op_sel_hi:[1,1]
    v_cvt_pk_bf16_f32 v36, v136, v137
    v_cvt_pk_bf16_f32 v37, v138, v139
    v_cvt_pk_bf16_f32 v38, v140, v141
    v_cvt_pk_bf16_f32 v39, v142, v143
    s_waitcnt lgkmcnt(0)
    s_barrier
    ds_read_b128 v[28:31], v22
    ds_read_b64_tr_b16 v[112:113], v23 offset:0
    ds_read_b64_tr_b16 v[114:115], v23 offset:1152
    ds_read_b64_tr_b16 v[116:117], v23 offset:2304
    ds_read_b64_tr_b16 v[118:119], v23 offset:3456
    ds_read_b64_tr_b16 v[120:121], v23 offset:4608
    ds_read_b64_tr_b16 v[122:123], v23 offset:5760
    ds_read_b64_tr_b16 v[124:125], v23 offset:6912
    ds_read_b64_tr_b16 v[136:137], v23 offset:32
    ds_read_b64_tr_b16 v[138:139], v23 offset:1184
    ds_read_b64_tr_b16 v[140:141], v23 offset:2336
    ds_read_b64_tr_b16 v[142:143], v23 offset:3488
    ds_read_b64_tr_b16 v[144:145], v23 offset:4640
    ds_read_b64_tr_b16 v[146:147], v23 offset:5792
    ds_read_b64_tr_b16 v[148:149], v23 offset:6944
    v_pk_fma_f32 v[160:161], v[72:73], v[60:61], v[160:161] op_sel:[0,0,0] op_sel_hi:[1,0,1]
    v_pk_fma_f32 v[162:163], v[74:75], v[60:61], v[162:163] op_sel:[0,0,0] op_sel_hi:[1,0,1]
    v_pk_fma_f32 v[164:165], v[76:77], v[60:61], v[164:165] op_sel:[0,0,0] op_sel_hi:[1,0,1]
    v_pk_fma_f32 v[166:167], v[78:79], v[60:61], v[166:167] op_sel:[0,0,0] op_sel_hi:[1,0,1]
    v_pk_mul_f32 v[160:161], v[160:161], v[60:61] op_sel:[0,1] op_sel_hi:[1,1]
    v_pk_mul_f32 v[162:163], v[162:163], v[60:61] op_sel:[0,1] op_sel_hi:[1,1]
    v_pk_mul_f32 v[164:165], v[164:165], v[60:61] op_sel:[0,1] op_sel_hi:[1,1]
    v_pk_mul_f32 v[166:167], v[166:167], v[60:61] op_sel:[0,1] op_sel_hi:[1,1]
    v_cvt_pk_bf16_f32 v40, v160, v161
    v_cvt_pk_bf16_f32 v41, v162, v163
    v_cvt_pk_bf16_f32 v42, v164, v165
    v_cvt_pk_bf16_f32 v43, v166, v167
    v_pk_fma_f32 v[184:185], v[72:73], v[62:63], v[184:185] op_sel:[0,0,0] op_sel_hi:[1,0,1]
    v_pk_fma_f32 v[186:187], v[74:75], v[62:63], v[186:187] op_sel:[0,0,0] op_sel_hi:[1,0,1]
    v_pk_fma_f32 v[188:189], v[76:77], v[62:63], v[188:189] op_sel:[0,0,0] op_sel_hi:[1,0,1]
    v_pk_fma_f32 v[190:191], v[78:79], v[62:63], v[190:191] op_sel:[0,0,0] op_sel_hi:[1,0,1]
    v_pk_mul_f32 v[184:185], v[184:185], v[62:63] op_sel:[0,1] op_sel_hi:[1,1]
    v_pk_mul_f32 v[186:187], v[186:187], v[62:63] op_sel:[0,1] op_sel_hi:[1,1]
    v_pk_mul_f32 v[188:189], v[188:189], v[62:63] op_sel:[0,1] op_sel_hi:[1,1]
    v_pk_mul_f32 v[190:191], v[190:191], v[62:63] op_sel:[0,1] op_sel_hi:[1,1]
    v_cvt_pk_bf16_f32 v44, v184, v185
    v_cvt_pk_bf16_f32 v45, v186, v187
    v_cvt_pk_bf16_f32 v46, v188, v189
    v_cvt_pk_bf16_f32 v47, v190, v191
    v_mov_b32_dpp v72, v224 row_newbcast:15 row_mask:0xf bank_mask:0xf
    v_mov_b32_dpp v73, v225 row_newbcast:15 row_mask:0xf bank_mask:0xf
    v_mov_b32_dpp v74, v226 row_newbcast:15 row_mask:0xf bank_mask:0xf
    v_mov_b32_dpp v75, v227 row_newbcast:15 row_mask:0xf bank_mask:0xf
    v_mov_b32_dpp v76, v228 row_newbcast:15 row_mask:0xf bank_mask:0xf
    v_mov_b32_dpp v77, v229 row_newbcast:15 row_mask:0xf bank_mask:0xf
    v_mov_b32_dpp v78, v230 row_newbcast:15 row_mask:0xf bank_mask:0xf
    v_mov_b32_dpp v79, v231 row_newbcast:15 row_mask:0xf bank_mask:0xf
    v_pk_fma_f32 v[104:105], v[72:73], v[56:57], v[104:105] op_sel:[0,0,0] op_sel_hi:[1,0,1]
    v_pk_fma_f32 v[106:107], v[74:75], v[56:57], v[106:107] op_sel:[0,0,0] op_sel_hi:[1,0,1]
    v_pk_fma_f32 v[108:109], v[76:77], v[56:57], v[108:109] op_sel:[0,0,0] op_sel_hi:[1,0,1]
    v_pk_fma_f32 v[110:111], v[78:79], v[56:57], v[110:111] op_sel:[0,0,0] op_sel_hi:[1,0,1]
    v_pk_mul_f32 v[104:105], v[104:105], v[56:57] op_sel:[0,1] op_sel_hi:[1,1]
    v_pk_mul_f32 v[106:107], v[106:107], v[56:57] op_sel:[0,1] op_sel_hi:[1,1]
    v_pk_mul_f32 v[108:109], v[108:109], v[56:57] op_sel:[0,1] op_sel_hi:[1,1]
    v_pk_mul_f32 v[110:111], v[110:111], v[56:57] op_sel:[0,1] op_sel_hi:[1,1]
    v_cvt_pk_bf16_f32 v160, v104, v105
    v_cvt_pk_bf16_f32 v161, v106, v107
    v_cvt_pk_bf16_f32 v162, v108, v109
    v_cvt_pk_bf16_f32 v163, v110, v111
    v_pk_fma_f32 v[128:129], v[72:73], v[58:59], v[128:129] op_sel:[0,0,0] op_sel_hi:[1,0,1]
    v_pk_fma_f32 v[130:131], v[74:75], v[58:59], v[130:131] op_sel:[0,0,0] op_sel_hi:[1,0,1]
    v_pk_fma_f32 v[132:133], v[76:77], v[58:59], v[132:133] op_sel:[0,0,0] op_sel_hi:[1,0,1]
    v_pk_fma_f32 v[134:135], v[78:79], v[58:59], v[134:135] op_sel:[0,0,0] op_sel_hi:[1,0,1]
    v_pk_mul_f32 v[128:129], v[128:129], v[58:59] op_sel:[0,1] op_sel_hi:[1,1]
    v_pk_mul_f32 v[130:131], v[130:131], v[58:59] op_sel:[0,1] op_sel_hi:[1,1]
    v_pk_mul_f32 v[132:133], v[132:133], v[58:59] op_sel:[0,1] op_sel_hi:[1,1]
    v_pk_mul_f32 v[134:135], v[134:135], v[58:59] op_sel:[0,1] op_sel_hi:[1,1]
    v_cvt_pk_bf16_f32 v164, v128, v129
    v_cvt_pk_bf16_f32 v165, v130, v131
    v_cvt_pk_bf16_f32 v166, v132, v133
    v_cvt_pk_bf16_f32 v167, v134, v135
    v_pk_fma_f32 v[152:153], v[72:73], v[60:61], v[152:153] op_sel:[0,0,0] op_sel_hi:[1,0,1]
    v_pk_fma_f32 v[154:155], v[74:75], v[60:61], v[154:155] op_sel:[0,0,0] op_sel_hi:[1,0,1]
    v_pk_fma_f32 v[156:157], v[76:77], v[60:61], v[156:157] op_sel:[0,0,0] op_sel_hi:[1,0,1]
    v_pk_fma_f32 v[158:159], v[78:79], v[60:61], v[158:159] op_sel:[0,0,0] op_sel_hi:[1,0,1]
    v_pk_mul_f32 v[152:153], v[152:153], v[60:61] op_sel:[0,1] op_sel_hi:[1,1]
    v_pk_mul_f32 v[154:155], v[154:155], v[60:61] op_sel:[0,1] op_sel_hi:[1,1]
    v_pk_mul_f32 v[156:157], v[156:157], v[60:61] op_sel:[0,1] op_sel_hi:[1,1]
    v_pk_mul_f32 v[158:159], v[158:159], v[60:61] op_sel:[0,1] op_sel_hi:[1,1]
    v_cvt_pk_bf16_f32 v168, v152, v153
    v_cvt_pk_bf16_f32 v169, v154, v155
    v_cvt_pk_bf16_f32 v170, v156, v157
    v_cvt_pk_bf16_f32 v171, v158, v159
    v_pk_fma_f32 v[176:177], v[72:73], v[62:63], v[176:177] op_sel:[0,0,0] op_sel_hi:[1,0,1]
    v_pk_fma_f32 v[178:179], v[74:75], v[62:63], v[178:179] op_sel:[0,0,0] op_sel_hi:[1,0,1]
    v_pk_fma_f32 v[180:181], v[76:77], v[62:63], v[180:181] op_sel:[0,0,0] op_sel_hi:[1,0,1]
    v_pk_fma_f32 v[182:183], v[78:79], v[62:63], v[182:183] op_sel:[0,0,0] op_sel_hi:[1,0,1]
    v_pk_mul_f32 v[176:177], v[176:177], v[62:63] op_sel:[0,1] op_sel_hi:[1,1]
    v_pk_mul_f32 v[178:179], v[178:179], v[62:63] op_sel:[0,1] op_sel_hi:[1,1]
    v_pk_mul_f32 v[180:181], v[180:181], v[62:63] op_sel:[0,1] op_sel_hi:[1,1]
    v_pk_mul_f32 v[182:183], v[182:183], v[62:63] op_sel:[0,1] op_sel_hi:[1,1]
    v_cvt_pk_bf16_f32 v172, v176, v177
    v_cvt_pk_bf16_f32 v173, v178, v179
    v_cvt_pk_bf16_f32 v174, v180, v181
    v_cvt_pk_bf16_f32 v175, v182, v183
    v_pk_fma_f32 v[200:201], v[72:73], v[64:65], v[200:201] op_sel:[0,0,0] op_sel_hi:[1,0,1]
    v_pk_fma_f32 v[202:203], v[74:75], v[64:65], v[202:203] op_sel:[0,0,0] op_sel_hi:[1,0,1]
    v_pk_fma_f32 v[204:205], v[76:77], v[64:65], v[204:205] op_sel:[0,0,0] op_sel_hi:[1,0,1]
    v_pk_fma_f32 v[206:207], v[78:79], v[64:65], v[206:207] op_sel:[0,0,0] op_sel_hi:[1,0,1]
    v_pk_mul_f32 v[200:201], v[200:201], v[64:65] op_sel:[0,1] op_sel_hi:[1,1]
    v_pk_mul_f32 v[202:203], v[202:203], v[64:65] op_sel:[0,1] op_sel_hi:[1,1]
    v_pk_mul_f32 v[204:205], v[204:205], v[64:65] op_sel:[0,1] op_sel_hi:[1,1]
    v_pk_mul_f32 v[206:207], v[206:207], v[64:65] op_sel:[0,1] op_sel_hi:[1,1]
    v_cvt_pk_bf16_f32 v184, v200, v201
    v_cvt_pk_bf16_f32 v185, v202, v203
    v_cvt_pk_bf16_f32 v186, v204, v205
    v_cvt_pk_bf16_f32 v187, v206, v207
    v_pk_fma_f32 v[224:225], v[72:73], v[66:67], v[224:225] op_sel:[0,0,0] op_sel_hi:[1,0,1]
    v_pk_fma_f32 v[226:227], v[74:75], v[66:67], v[226:227] op_sel:[0,0,0] op_sel_hi:[1,0,1]
    v_pk_fma_f32 v[228:229], v[76:77], v[66:67], v[228:229] op_sel:[0,0,0] op_sel_hi:[1,0,1]
    v_pk_fma_f32 v[230:231], v[78:79], v[66:67], v[230:231] op_sel:[0,0,0] op_sel_hi:[1,0,1]
    v_pk_mul_f32 v[224:225], v[224:225], v[66:67] op_sel:[0,1] op_sel_hi:[1,1]
    v_pk_mul_f32 v[226:227], v[226:227], v[66:67] op_sel:[0,1] op_sel_hi:[1,1]
    v_pk_mul_f32 v[228:229], v[228:229], v[66:67] op_sel:[0,1] op_sel_hi:[1,1]
    v_pk_mul_f32 v[230:231], v[230:231], v[66:67] op_sel:[0,1] op_sel_hi:[1,1]
    v_cvt_pk_bf16_f32 v188, v224, v225
    v_cvt_pk_bf16_f32 v189, v226, v227
    v_cvt_pk_bf16_f32 v190, v228, v229
    v_cvt_pk_bf16_f32 v191, v230, v231
    s_waitcnt lgkmcnt(14)
    v_mfma_f32_16x16x32_bf16 v[104:107], v[32:35], v[160:163], 0
    v_mfma_f32_16x16x32_bf16 v[108:111], v[28:31], v[160:163], 0
    v_mov_b32 v84, 0x0c0c0100
    v_mov_b32 v85, 0x01000c0c
    v_cndmask_b32 v84, v84, v85, s[56:57]
    v_mov_b32 v85, 0x0c0c0c0c
    v_mfma_f32_16x16x32_bf16 v[128:131], v[36:39], v[164:167], 0
    v_mfma_f32_16x16x32_bf16 v[132:135], v[32:35], v[164:167], 0
    v_cndmask_b32 v80, v84, v85, s[58:59]
    v_cndmask_b32 v82, v85, v84, s[58:59]
    v_mov_b32 v84, 0x0c0c0302
    v_mov_b32 v81, 0x03020c0c
    v_mfma_f32_16x16x32_bf16 v[152:155], v[40:43], v[168:171], 0
    v_mfma_f32_16x16x32_bf16 v[156:159], v[36:39], v[168:171], 0
    v_cndmask_b32 v84, v84, v81, s[56:57]
    v_cndmask_b32 v81, v84, v85, s[60:61]
    v_cndmask_b32 v83, v85, v84, s[60:61]
    v_mfma_f32_16x16x32_bf16 v[176:179], v[44:47], v[172:175], 0
    v_mfma_f32_16x16x32_bf16 v[180:183], v[40:43], v[172:175], 0
    v_mfma_f32_16x16x32_bf16 v[200:203], v[48:51], v[184:187], 0
    v_mfma_f32_16x16x32_bf16 v[204:207], v[44:47], v[184:187], 0
    v_mfma_f32_16x16x32_bf16 v[224:227], v[52:55], v[188:191], 0
    v_mfma_f32_16x16x32_bf16 v[228:231], v[48:51], v[188:191], 0
    s_or_b32 s43, s50, s52
    s_cmp_lg_u32 s43, 0
    s_cbranch_scc1 Q_NOMASK
    v_mov_b32 v108, 0xcf9db2f6
    v_mov_b32 v109, 0xcf9db2f6
    v_mov_b32 v110, 0xcf9db2f6
    v_mov_b32 v111, 0xcf9db2f6
Q_NOMASK:
    v_cndmask_b32 v208, v104, v105, s[56:57]
    v_cndmask_b32 v209, v106, v107, s[56:57]
    v_cndmask_b32 v210, v108, v109, s[56:57]
    v_cndmask_b32 v211, v110, v111, s[56:57]
    v_cndmask_b32 v208, v210, v208, s[58:59]
    v_cndmask_b32 v209, v211, v209, s[60:61]
    v_cvt_pk_bf16_f32 v210, v208, v209
    v_lshlrev_b32 v208, 16, v210
    v_and_b32 v209, s32, v210
    v_pk_mul_f32 v[208:209], v[208:209], s[62:63]
    v_cvt_pk_bf16_f32 v210, v208, v209
    v_lshlrev_b32 v208, 16, v210
    v_and_b32 v209, s32, v210
    v_max_f32 v210, v208, v209
    v_cndmask_b32 v212, v128, v129, s[56:57]
    v_cndmask_b32 v213, v130, v131, s[56:57]
    v_cndmask_b32 v214, v132, v133, s[56:57]
    v_cndmask_b32 v215, v134, v135, s[56:57]
    v_cndmask_b32 v212, v214, v212, s[58:59]
    v_cndmask_b32 v213, v215, v213, s[60:61]
    v_cvt_pk_bf16_f32 v214, v212, v213
    v_lshlrev_b32 v212, 16, v214
    v_and_b32 v213, s32, v214
    v_pk_mul_f32 v[212:213], v[212:213], s[62:63]
    v_cvt_pk_bf16_f32 v214, v212, v213
    v_lshlrev_b32 v212, 16, v214
    v_and_b32 v213, s32, v214
    v_max_f32 v214, v212, v213
    v_cndmask_b32 v216, v152, v153, s[56:57]
    v_cndmask_b32 v217, v154, v155, s[56:57]
    v_cndmask_b32 v218, v156, v157, s[56:57]
    v_cndmask_b32 v219, v158, v159, s[56:57]
    v_cndmask_b32 v216, v218, v216, s[58:59]
    v_cndmask_b32 v217, v219, v217, s[60:61]
    v_cvt_pk_bf16_f32 v218, v216, v217
    v_lshlrev_b32 v216, 16, v218
    v_and_b32 v217, s32, v218
    v_pk_mul_f32 v[216:217], v[216:217], s[62:63]
    v_cvt_pk_bf16_f32 v218, v216, v217
    v_lshlrev_b32 v216, 16, v218
    v_and_b32 v217, s32, v218
    v_max_f32 v218, v216, v217
    v_cndmask_b32 v220, v176, v177, s[56:57]
    v_cndmask_b32 v221, v178, v179, s[56:57]
    v_cndmask_b32 v222, v180, v181, s[56:57]
    v_cndmask_b32 v223, v182, v183, s[56:57]
    v_cndmask_b32 v220, v222, v220, s[58:59]
    v_cndmask_b32 v221, v223, v221, s[60:61]
    v_cvt_pk_bf16_f32 v222, v220, v221
    v_lshlrev_b32 v220, 16, v222
    v_and_b32 v221, s32, v222
    v_pk_mul_f32 v[220:221], v[220:221], s[62:63]
    v_cvt_pk_bf16_f32 v222, v220, v221
    v_lshlrev_b32 v220, 16, v222
    v_and_b32 v221, s32, v222
    v_max_f32 v222, v220, v221
    v_cndmask_b32 v232, v200, v201, s[56:57]
    v_cndmask_b32 v233, v202, v203, s[56:57]
    v_cndmask_b32 v234, v204, v205, s[56:57]
    v_cndmask_b32 v235, v206, v207, s[56:57]
    v_cndmask_b32 v232, v234, v232, s[58:59]
    v_cndmask_b32 v233, v235, v233, s[60:61]
    v_cvt_pk_bf16_f32 v234, v232, v233
    v_lshlrev_b32 v232, 16, v234
    v_and_b32 v233, s32, v234
    v_pk_mul_f32 v[232:233], v[232:233], s[62:63]
    v_cvt_pk_bf16_f32 v234, v232, v233
    v_lshlrev_b32 v232, 16, v234
    v_and_b32 v233, s32, v234
    v_max_f32 v234, v232, v233
    v_cndmask_b32 v236, v224, v225, s[56:57]
    v_cndmask_b32 v237, v226, v227, s[56:57]
    v_cndmask_b32 v238, v228, v229, s[56:57]
    v_cndmask_b32 v239, v230, v231, s[56:57]
    v_cndmask_b32 v236, v238, v236, s[58:59]
    v_cndmask_b32 v237, v239, v237, s[60:61]
    v_cvt_pk_bf16_f32 v238, v236, v237
    v_lshlrev_b32 v236, 16, v238
    v_and_b32 v237, s32, v238
    v_pk_mul_f32 v[236:237], v[236:237], s[62:63]
    v_cvt_pk_bf16_f32 v238, v236, v237
    v_lshlrev_b32 v236, 16, v238
    v_and_b32 v237, s32, v238
    v_max_f32 v238, v236, v237
    s_nop 0
    v_permlane16_swap_b32 v210, v214
    v_permlane16_swap_b32 v218, v222
    v_permlane16_swap_b32 v234, v238
    v_max_f32 v210, v210, v214
    v_mov_b32 v214, v210
    v_max_f32 v218, v218, v222
    v_mov_b32 v222, v218
    v_max_f32 v234, v234, v238
    v_mov_b32 v238, v234
    v_permlane32_swap_b32 v210, v214
    v_permlane32_swap_b32 v218, v222
    v_permlane32_swap_b32 v234, v238
    v_max_f32 v210, v210, v214
    v_max_f32 v218, v218, v222
    v_max_f32 v234, v234, v238
    v_mul_f32 v210, 0xbfb8aa3b, v210
    v_mul_f32 v218, 0xbfb8aa3b, v218
    v_mul_f32 v234, 0xbfb8aa3b, v234
    v_mov_b32 v214, v210
    v_mov_b32 v222, v218
    v_mov_b32 v238, v234
    v_permlane16_swap_b32 v210, v214
    v_permlane16_swap_b32 v218, v222
    v_permlane16_swap_b32 v234, v238
    v_pk_fma_f32 v[208:209], v[208:209], s[64:65], v[210:211] op_sel:[0,0,0] op_sel_hi:[1,1,0]
    v_pk_fma_f32 v[212:213], v[212:213], s[64:65], v[214:215] op_sel:[0,0,0] op_sel_hi:[1,1,0]
    v_pk_fma_f32 v[216:217], v[216:217], s[64:65], v[218:219] op_sel:[0,0,0] op_sel_hi:[1,1,0]
    v_pk_fma_f32 v[220:221], v[220:221], s[64:65], v[222:223] op_sel:[0,0,0] op_sel_hi:[1,1,0]
    v_pk_fma_f32 v[232:233], v[232:233], s[64:65], v[234:235] op_sel:[0,0,0] op_sel_hi:[1,1,0]
    v_pk_fma_f32 v[236:237], v[236:237], s[64:65], v[238:239] op_sel:[0,0,0] op_sel_hi:[1,1,0]
    v_exp_f32 v208, v208
    v_exp_f32 v209, v209
    v_exp_f32 v212, v212
    v_exp_f32 v213, v213
    v_exp_f32 v216, v216
    v_exp_f32 v217, v217
    v_exp_f32 v220, v220
    v_exp_f32 v221, v221
    v_exp_f32 v232, v232
    v_exp_f32 v233, v233
    v_exp_f32 v236, v236
    v_exp_f32 v237, v237
    v_add_f32 v210, v208, v209
    v_add_f32 v214, v212, v213
    v_add_f32 v218, v216, v217
    v_add_f32 v222, v220, v221
    v_add_f32 v234, v232, v233
    v_add_f32 v238, v236, v237
    s_nop 0
    v_permlane16_swap_b32 v210, v214
    v_permlane16_swap_b32 v218, v222
    v_permlane16_swap_b32 v234, v238
    v_add_f32 v210, v210, v214
    v_mov_b32 v214, v210
    v_add_f32 v218, v218, v222
    v_mov_b32 v222, v218
    v_add_f32 v234, v234, v238
    v_mov_b32 v238, v234
    v_permlane32_swap_b32 v210, v214
    v_permlane32_swap_b32 v218, v222
    v_permlane32_swap_b32 v234, v238
    v_add_f32 v210, v210, v214
    v_add_f32 v218, v218, v222
    v_add_f32 v234, v234, v238
    v_rcp_f32 v210, v210
    v_rcp_f32 v218, v218
    v_rcp_f32 v234, v234
    v_mov_b32 v214, v210
    v_mov_b32 v222, v218
    v_mov_b32 v238, v234
    v_permlane16_swap_b32 v210, v214
    v_permlane16_swap_b32 v218, v222
    v_permlane16_swap_b32 v234, v238
    v_pk_mul_f32 v[208:209], v[208:209], v[210:211] op_sel:[0,0] op_sel_hi:[1,0]
    v_pk_mul_f32 v[212:213], v[212:213], v[214:215] op_sel:[0,0] op_sel_hi:[1,0]
    v_pk_mul_f32 v[216:217], v[216:217], v[218:219] op_sel:[0,0] op_sel_hi:[1,0]
    v_pk_mul_f32 v[220:221], v[220:221], v[222:223] op_sel:[0,0] op_sel_hi:[1,0]
    v_pk_mul_f32 v[232:233], v[232:233], v[234:235] op_sel:[0,0] op_sel_hi:[1,0]
    v_pk_mul_f32 v[236:237], v[236:237], v[238:239] op_sel:[0,0] op_sel_hi:[1,0]
    s_waitcnt lgkmcnt(0)
    v_cvt_pk_bf16_f32 v211, v208, v209
    v_perm_b32 v28, v211, v211, v80
    v_perm_b32 v29, v211, v211, v81
    v_perm_b32 v30, v211, v211, v82
    v_perm_b32 v31, v211, v211, v83
    v_cvt_pk_bf16_f32 v215, v212, v213
    v_perm_b32 v32, v215, v215, v80
    v_perm_b32 v33, v215, v215, v81
    v_perm_b32 v34, v215, v215, v82
    v_perm_b32 v35, v215, v215, v83
    v_mfma_f32_16x16x32_bf16 v[104:107], v[112:115], v[28:31], 0
    v_mfma_f32_16x16x32_bf16 v[108:111], v[136:139], v[28:31], 0
    v_cvt_pk_bf16_f32 v219, v216, v217
    v_perm_b32 v36, v219, v219, v80
    v_perm_b32 v37, v219, v219, v81
    v_perm_b32 v38, v219, v219, v82
    v_perm_b32 v39, v219, v219, v83
    v_mfma_f32_16x16x32_bf16 v[128:131], v[114:117], v[32:35], 0
    v_mfma_f32_16x16x32_bf16 v[132:135], v[138:141], v[32:35], 0
    v_cvt_pk_bf16_f32 v223, v220, v221
    v_perm_b32 v40, v223, v223, v80
    v_perm_b32 v41, v223, v223, v81
    v_perm_b32 v42, v223, v223, v82
    v_perm_b32 v43, v223, v223, v83
    v_mfma_f32_16x16x32_bf16 v[152:155], v[116:119], v[36:39], 0
    v_mfma_f32_16x16x32_bf16 v[156:159], v[140:143], v[36:39], 0
    v_cvt_pk_bf16_f32 v235, v232, v233
    v_perm_b32 v44, v235, v235, v80
    v_perm_b32 v45, v235, v235, v81
    v_perm_b32 v46, v235, v235, v82
    v_perm_b32 v47, v235, v235, v83
    v_mfma_f32_16x16x32_bf16 v[176:179], v[118:121], v[40:43], 0
    v_mfma_f32_16x16x32_bf16 v[180:183], v[142:145], v[40:43], 0
    v_cvt_pk_bf16_f32 v239, v236, v237
    v_perm_b32 v48, v239, v239, v80
    v_perm_b32 v49, v239, v239, v81
    v_perm_b32 v50, v239, v239, v82
    v_perm_b32 v51, v239, v239, v83
    v_mfma_f32_16x16x32_bf16 v[200:203], v[120:123], v[44:47], 0
    v_mfma_f32_16x16x32_bf16 v[204:207], v[144:147], v[44:47], 0
    s_nop 0
    v_mfma_f32_16x16x32_bf16 v[224:227], v[122:125], v[48:51], 0
    v_mfma_f32_16x16x32_bf16 v[228:231], v[146:149], v[48:51], 0
    v_cvt_pk_bf16_f32 v160, v104, v105
    v_cvt_pk_bf16_f32 v161, v106, v107
    v_cvt_pk_bf16_f32 v162, v108, v109
    v_cvt_pk_bf16_f32 v163, v110, v111
    s_mov_b32 s40, 0
    buffer_store_dwordx4 v[160:163], v24, s[28:31], s40 offen sc1
    v_cvt_pk_bf16_f32 v164, v128, v129
    v_cvt_pk_bf16_f32 v165, v130, v131
    v_cvt_pk_bf16_f32 v166, v132, v133
    v_cvt_pk_bf16_f32 v167, v134, v135
    s_mov_b32 s40, 16384
    buffer_store_dwordx4 v[164:167], v24, s[28:31], s40 offen sc1
    v_cvt_pk_bf16_f32 v168, v152, v153
    v_cvt_pk_bf16_f32 v169, v154, v155
    v_cvt_pk_bf16_f32 v170, v156, v157
    v_cvt_pk_bf16_f32 v171, v158, v159
    s_mov_b32 s40, 32768
    buffer_store_dwordx4 v[168:171], v24, s[28:31], s40 offen sc1
    v_cvt_pk_bf16_f32 v172, v176, v177
    v_cvt_pk_bf16_f32 v173, v178, v179
    v_cvt_pk_bf16_f32 v174, v180, v181
    v_cvt_pk_bf16_f32 v175, v182, v183
    s_mov_b32 s40, 49152
    buffer_store_dwordx4 v[172:175], v24, s[28:31], s40 offen sc1
    v_cvt_pk_bf16_f32 v184, v200, v201
    v_cvt_pk_bf16_f32 v185, v202, v203
    v_cvt_pk_bf16_f32 v186, v204, v205
    v_cvt_pk_bf16_f32 v187, v206, v207
    s_mov_b32 s40, 65536
    buffer_store_dwordx4 v[184:187], v24, s[28:31], s40 offen sc1
    v_cvt_pk_bf16_f32 v188, v224, v225
    v_cvt_pk_bf16_f32 v189, v226, v227
    v_cvt_pk_bf16_f32 v190, v228, v229
    v_cvt_pk_bf16_f32 v191, v230, v231
    s_mov_b32 s40, 81920
    buffer_store_dwordx4 v[188:191], v24, s[28:31], s40 offen sc1
    s_cmp_lt_u32 s79, 7
    s_cbranch_scc1 QC_TILE
    s_waitcnt vmcnt(0)
    s_barrier
    s_endpgm
QC_TILE:
    s_lshr_b32 s40, s33, 1
    s_and_b32 s41, s33, 1
    s_lshl_b32 s42, s78, 1
    s_add_u32 s42, s42, s40
    s_lshl_b32 s44, s42, 5
    s_mul_i32 s42, s42, 114688
    v_and_b32 v10, 1, v2
    v_mul_u32_u24 v11, 57344, v10
    v_lshl_add_u32 v11, v1, 4, v11
    v_lshrrev_b32 v9, 5, v0
    v_lshl_add_u32 v11, v9, 8, v11
    s_lshl_b32 s43, s41, 11
    s_add_u32 s43, s43, s42
    v_add_u32 v3, s43, v11
    v_and_b32 v11, 31, v0
    v_add_u32 v11, s44, v11
    v_mul_u32_u24 v12, 745, v11
    v_lshrrev_b32 v12, 17, v12
    v_sub_u32 v11, v11, v12
    v_min_u32 v11, 2047, v11
    v_mul_u32_u24 v12, 690, v11
    v_lshrrev_b32 v12, 16, v12
    v_mul_u32_u24 v4, 95, v12
    v_sub_u32 v11, v11, v4
    v_mul_u32_u24 v4, 6, v12
    v_lshrrev_b32 v12, 4, v11
    v_add_u32 v4, v4, v12
    v_lshlrev_b32 v4, 14, v4
    v_and_b32 v11, 15, v11
    v_lshl_add_u32 v4, v11, 4, v4
    v_lshl_add_u32 v4, v9, 8, v4
    s_lshl_b32 s43, s41, 13
    s_add_u32 s43, s43, 7569408
    v_add_u32 v4, s43, v4
    v_bfe_u32 v11, v0, 2, 2
    v_lshl_add_u32 v7, v9, 2, v11
    v_lshlrev_b32 v7, 7, v7
    v_and_b32 v11, 2, v11
    v_or_b32 v11, v11, v9
    v_xor_b32 v11, v11, v10
    v_lshl_add_u32 v7, v11, 5, v7
    v_and_b32 v11, 3, v0
    v_lshl_add_u32 v7, v11, 3, v7
    s_lshl_b32 s43, s41, 12
    v_add_u32 v5, s43, v7
    v_xor_b32 v6, 64, v5
    v_add_u32 v7, 49152, v5
    v_add_u32 v8, 49152, v6
    s_mul_i32 s43, s33, 8448
    s_add_u32 s43, s43, 16384
    v_lshl_add_u32 v9, v0, 4, s43
    s_barrier
    ds_read_b64_tr_b16 v[192:193], v7 offset:0
    ds_read_b64_tr_b16 v[194:195], v7 offset:2048
    ds_read_b64_tr_b16 v[196:197], v8 offset:0
    ds_read_b64_tr_b16 v[198:199], v8 offset:2048
    ds_read_b64_tr_b16 v[200:201], v7 offset:1024
    ds_read_b64_tr_b16 v[202:203], v7 offset:3072
    ds_read_b64_tr_b16 v[204:205], v8 offset:1024
    ds_read_b64_tr_b16 v[206:207], v8 offset:3072
    ds_read_b64_tr_b16 v[208:209], v7 offset:8192
    ds_read_b64_tr_b16 v[210:211], v7 offset:10240
    ds_read_b64_tr_b16 v[212:213], v8 offset:8192
    ds_read_b64_tr_b16 v[214:215], v8 offset:10240
    ds_read_b64_tr_b16 v[216:217], v7 offset:9216
    ds_read_b64_tr_b16 v[218:219], v7 offset:11264
    ds_read_b64_tr_b16 v[220:221], v8 offset:9216
    ds_read_b64_tr_b16 v[222:223], v8 offset:11264
    ds_read_b64_tr_b16 v[224:225], v7 offset:16384
    ds_read_b64_tr_b16 v[226:227], v7 offset:18432
    ds_read_b64_tr_b16 v[228:229], v8 offset:16384
    ds_read_b64_tr_b16 v[230:231], v8 offset:18432
    ds_read_b64_tr_b16 v[232:233], v7 offset:17408
    ds_read_b64_tr_b16 v[234:235], v7 offset:19456
    ds_read_b64_tr_b16 v[236:237], v8 offset:17408
    ds_read_b64_tr_b16 v[238:239], v8 offset:19456
    ds_read_b64_tr_b16 v[240:241], v7 offset:24576
    ds_read_b64_tr_b16 v[242:243], v7 offset:26624
    ds_read_b64_tr_b16 v[244:245], v8 offset:24576
    ds_read_b64_tr_b16 v[246:247], v8 offset:26624
    ds_read_b64_tr_b16 v[248:249], v7 offset:25600
    ds_read_b64_tr_b16 v[250:251], v7 offset:27648
    ds_read_b64_tr_b16 v[252:253], v8 offset:25600
    ds_read_b64_tr_b16 v[254:255], v8 offset:27648
    ds_read_b64_tr_b16 v[96:97], v7 offset:32768
    ds_read_b64_tr_b16 v[98:99], v7 offset:34816
    ds_read_b64_tr_b16 v[100:101], v8 offset:32768
    ds_read_b64_tr_b16 v[102:103], v8 offset:34816
    ds_read_b64_tr_b16 v[104:105], v7 offset:33792
    ds_read_b64_tr_b16 v[106:107], v7 offset:35840
    ds_read_b64_tr_b16 v[108:109], v8 offset:33792
    ds_read_b64_tr_b16 v[110:111], v8 offset:35840
    ds_read_b64_tr_b16 v[112:113], v7 offset:40960
    ds_read_b64_tr_b16 v[114:115], v7 offset:43008
    ds_read_b64_tr_b16 v[116:117], v8 offset:40960
    ds_read_b64_tr_b16 v[118:119], v8 offset:43008
    ds_read_b64_tr_b16 v[120:121], v7 offset:41984
    ds_read_b64_tr_b16 v[122:123], v7 offset:44032
    ds_read_b64_tr_b16 v[124:125], v8 offset:41984
    ds_read_b64_tr_b16 v[126:127], v8 offset:44032
    ds_read_b64_tr_b16 v[16:17], v7 offset:49152
    ds_read_b64_tr_b16 v[18:19], v7 offset:51200
    ds_read_b64_tr_b16 v[20:21], v8 offset:49152
    ds_read_b64_tr_b16 v[22:23], v8 offset:51200
    ds_read_b64_tr_b16 v[24:25], v7 offset:50176
    ds_read_b64_tr_b16 v[26:27], v7 offset:52224
    ds_read_b64_tr_b16 v[28:29], v8 offset:50176
    ds_read_b64_tr_b16 v[30:31], v8 offset:52224
    ds_read_b64_tr_b16 v[32:33], v7 offset:57344
    ds_read_b64_tr_b16 v[34:35], v7 offset:59392
    ds_read_b64_tr_b16 v[36:37], v8 offset:57344
    ds_read_b64_tr_b16 v[38:39], v8 offset:59392
    ds_read_b64_tr_b16 v[40:41], v7 offset:58368
    ds_read_b64_tr_b16 v[42:43], v7 offset:60416
    ds_read_b64_tr_b16 v[44:45], v8 offset:58368
    ds_read_b64_tr_b16 v[46:47], v8 offset:60416
    s_waitcnt lgkmcnt(0)
    s_waitcnt vmcnt(0)
    s_barrier
    s_branch P2_COMPUTE
P2_HELPER_Q:
    s_waitcnt vmcnt(0)
    s_setprio 0
    s_cmp_lg_u32 s14, 4
    s_cbranch_scc1 P2_HELPER_Q_H2_MID
    s_lshl_b32 s42, s78, 6
    s_add_u32 s43, s42, 63
    s_mul_i32 s40, s42, 5958
    s_lshr_b32 s40, s40, 20
    s_mul_i32 s41, s43, 5958
    s_lshr_b32 s41, s41, 20
    s_mov_b32 s43, 0x3fff3fff
    s_cmp_eq_u32 s40, s41
    s_cselect_b32 s42, 0x3fff, s43
    s_lshl_b32 s40, s40, 7
    s_add_u32 s40, s40, 0
    v_and_b32 v24, 1, v2
    v_lshlrev_b32 v24, 7, v24
    v_lshl_add_u32 v24, v1, 2, v24
    s_mov_b32 s44, 0
    buffer_load_dword v25, v24, s[64:67], s40 offen sc1
P2_HELPER_Q_H2_MID:
    v_add_u32 v14, 0, v12
    ds_write_b128 v14, v[80:83] offset:0
    ds_write_b128 v14, v[84:87] offset:4096
    ds_write_b128 v14, v[88:91] offset:8192
    ds_write_b128 v14, v[92:95] offset:12288
    ds_write_b128 v14, v[96:99] offset:16384
    ds_write_b128 v14, v[100:103] offset:20480
    ds_write_b128 v14, v[104:107] offset:24576
    ds_write_b128 v14, v[108:111] offset:28672
    ds_write_b128 v14, v[112:115] offset:32768
    ds_write_b128 v14, v[116:119] offset:36864
    ds_write_b128 v14, v[120:123] offset:40960
    ds_write_b128 v14, v[124:127] offset:45056
    ds_write_b128 v14, v[128:131] offset:49152
    ds_write_b128 v14, v[132:135] offset:53248
    s_waitcnt lgkmcnt(0)
    s_cmp_lg_u32 s14, 4
    s_cbranch_scc1 P2_HELPER_Q_H2_DONE
    s_branch P2_HELPER_Q_H2_CHK
P2_HELPER_Q_H2_LOOP:
    buffer_load_dword v25, v24, s[64:67], s40 offen sc1
P2_HELPER_Q_H2_CHK:
    s_add_u32 s44, s44, 1
    s_waitcnt vmcnt(0)
    v_cmp_eq_u32 vcc, v63, v25
    s_cmp_ge_u32 s44, 60000
    s_cbranch_scc1 P2_HELPER_Q_H2_DONE
    s_nop 1
    s_andn2_b32 s45, s42, vcc_lo
    s_cbranch_scc1 P2_HELPER_Q_H2_LOOP
P2_HELPER_Q_H2_DONE:
    s_barrier
    v_add_u32 v14, 57344, v12
    ds_write_b128 v14, v[136:139] offset:0
    ds_write_b128 v14, v[140:143] offset:4096
    ds_write_b128 v14, v[144:147] offset:8192
    ds_write_b128 v14, v[148:151] offset:12288
    ds_write_b128 v14, v[152:155] offset:16384
    ds_write_b128 v14, v[156:159] offset:20480
    ds_write_b128 v14, v[160:163] offset:24576
    ds_write_b128 v14, v[164:167] offset:28672
    s_waitcnt lgkmcnt(0)
    s_barrier
    s_cmp_lg_u32 s14, 4
    s_cbranch_scc1 P2_HELPER_Q_PO_MID
    s_lshl_b32 s42, s78, 6
    s_add_u32 s43, s42, 63
    s_mul_i32 s40, s42, 5958
    s_lshr_b32 s40, s40, 20
    s_mul_i32 s41, s43, 5958
    s_lshr_b32 s41, s41, 20
    s_sub_u32 s42, s42, s40
    s_sub_u32 s43, s43, s41
    s_min_u32 s43, s43, 2047
    s_mul_i32 s40, s42, 5519
    s_lshr_b32 s40, s40, 20
    s_mul_i32 s41, s43, 5519
    s_lshr_b32 s41, s41, 20
    s_mov_b32 s43, 0xff00ff
    s_cmp_eq_u32 s40, s41
    s_cselect_b32 s42, 0xff, s43
    s_lshl_b32 s40, s40, 7
    s_add_u32 s40, s40, 1536
    v_and_b32 v24, 1, v2
    v_lshlrev_b32 v24, 7, v24
    v_lshl_add_u32 v24, v1, 2, v24
    s_mov_b32 s44, 0
    buffer_load_dword v25, v24, s[64:67], s40 offen sc1
P2_HELPER_Q_PO_MID:
    v_add_u32 v14, 90112, v12
    ds_write_b128 v14, v[168:171] offset:0
    ds_write_b128 v14, v[172:175] offset:4096
    ds_write_b128 v14, v[176:179] offset:8192
    ds_write_b128 v14, v[180:183] offset:12288
    ds_write_b128 v14, v[184:187] offset:16384
    ds_write_b128 v14, v[188:191] offset:20480
    ds_write_b128 v14, v[192:195] offset:24576
    ds_write_b128 v14, v[196:199] offset:28672
    ds_write_b128 v14, v[200:203] offset:32768
    ds_write_b128 v14, v[204:207] offset:36864
    s_waitcnt lgkmcnt(0)
    s_cmp_lg_u32 s14, 4
    s_cbranch_scc1 P2_HELPER_Q_PO_DONE
    s_branch P2_HELPER_Q_PO_CHK
P2_HELPER_Q_PO_LOOP:
    buffer_load_dword v25, v24, s[64:67], s40 offen sc1
P2_HELPER_Q_PO_CHK:
    s_add_u32 s44, s44, 1
    s_waitcnt vmcnt(0)
    v_cmp_eq_u32 vcc, v63, v25
    s_cmp_ge_u32 s44, 60000
    s_cbranch_scc1 P2_HELPER_Q_PO_DONE
    s_nop 1
    s_andn2_b32 s45, s42, vcc_lo
    s_cbranch_scc1 P2_HELPER_Q_PO_LOOP
P2_HELPER_Q_PO_DONE:
    s_barrier
    buffer_load_dword v26, v10, s[28:31], 0 offen sc1
    buffer_load_dword v27, v11, s[28:31], 0 offen sc1
    buffer_load_dwordx4 v[16:19], v8, s[16:19], 0 offen
    buffer_load_dwordx4 v[20:23], v9, s[16:19], 0 offen
    v_add_u32 v14, 131072, v12
    ds_write_b128 v14, v[208:211] offset:0
    ds_write_b128 v14, v[212:215] offset:4096
    ds_write_b128 v14, v[216:219] offset:8192
    ds_write_b128 v14, v[220:223] offset:12288
    ds_write_b128 v14, v[224:227] offset:16384
    ds_write_b128 v14, v[228:231] offset:20480
    ds_write_b128 v14, v[232:235] offset:24576
    ds_write_b128 v14, v[236:239] offset:28672
    v_add_u32 v14, 0, v12
    ds_write_b128 v14, v[240:243] offset:0
    ds_write_b128 v14, v[244:247] offset:4096
    ds_write_b128 v14, v[248:251] offset:8192
    ds_write_b128 v14, v[252:255] offset:12288
    s_waitcnt lgkmcnt(0)
    s_waitcnt vmcnt(0)
    v_and_b32 v26, s32, v26
    v_and_b32 v27, s32, v27
    v_rcp_f32 v26, v26
    v_rcp_f32 v27, v27
    v_lshlrev_b32 v32, 16, v16
    v_and_b32 v33, s32, v16
    v_lshlrev_b32 v34, 16, v17
    v_and_b32 v35, s32, v17
    v_lshlrev_b32 v36, 16, v18
    v_and_b32 v37, s32, v18
    v_lshlrev_b32 v38, 16, v19
    v_and_b32 v39, s32, v19
    v_lshlrev_b32 v40, 16, v20
    v_and_b32 v41, s32, v20
    v_lshlrev_b32 v42, 16, v21
    v_and_b32 v43, s32, v21
    v_lshlrev_b32 v44, 16, v22
    v_and_b32 v45, s32, v22
    v_lshlrev_b32 v46, 16, v23
    v_and_b32 v47, s32, v23
    v_mul_f32 v26, v26, v26
    v_mul_f32 v27, v27, v27
    s_barrier
    s_barrier
    s_branch P2_HFIN
P2_HELPER:
    s_waitcnt vmcnt(0)
    s_setprio 0
    s_cmp_lg_u32 s14, 4
    s_cbranch_scc1 P2_HELPER_H2_DONE
    s_lshl_b32 s42, s78, 6
    s_add_u32 s43, s42, 63
    s_mul_i32 s40, s42, 5958
    s_lshr_b32 s40, s40, 20
    s_mul_i32 s41, s43, 5958
    s_lshr_b32 s41, s41, 20
    s_mov_b32 s43, 0x3fff3fff
    s_cmp_eq_u32 s40, s41
    s_cselect_b32 s42, 0x3fff, s43
    s_lshl_b32 s40, s40, 7
    s_add_u32 s40, s40, 0
    v_and_b32 v24, 1, v2
    v_lshlrev_b32 v24, 7, v24
    v_lshl_add_u32 v24, v1, 2, v24
    s_mov_b32 s44, 0
P2_HELPER_H2_LOOP:
    buffer_load_dword v25, v24, s[64:67], s40 offen sc1
P2_HELPER_H2_CHK:
    s_add_u32 s44, s44, 1
    s_waitcnt vmcnt(0)
    v_cmp_eq_u32 vcc, v63, v25
    s_cmp_ge_u32 s44, 60000
    s_cbranch_scc1 P2_HELPER_H2_DONE
    s_nop 1
    s_andn2_b32 s45, s42, vcc_lo
    s_cbranch_scc1 P2_HELPER_H2_LOOP
P2_HELPER_H2_DONE:
    s_barrier
    v_add_u32 v14, 114688, v12
    ds_write_b128 v14, v[192:195] offset:0
    ds_write_b128 v14, v[196:199] offset:4096
    s_waitcnt lgkmcnt(0)
    s_barrier
    s_cmp_lg_u32 s14, 4
    s_cbranch_scc1 P2_HELPER_PO_MID
    s_lshl_b32 s42, s78, 6
    s_add_u32 s43, s42, 63
    s_mul_i32 s40, s42, 5958
    s_lshr_b32 s40, s40, 20
    s_mul_i32 s41, s43, 5958
    s_lshr_b32 s41, s41, 20
    s_sub_u32 s42, s42, s40
    s_sub_u32 s43, s43, s41
    s_min_u32 s43, s43, 2047
    s_mul_i32 s40, s42, 5519
    s_lshr_b32 s40, s40, 20
    s_mul_i32 s41, s43, 5519
    s_lshr_b32 s41, s41, 20
    s_mov_b32 s43, 0xff00ff
    s_cmp_eq_u32 s40, s41
    s_cselect_b32 s42, 0xff, s43
    s_lshl_b32 s40, s40, 7
    s_add_u32 s40, s40, 1536
    v_and_b32 v24, 1, v2
    v_lshlrev_b32 v24, 7, v24
    v_lshl_add_u32 v24, v1, 2, v24
    s_mov_b32 s44, 0
    buffer_load_dword v25, v24, s[64:67], s40 offen sc1
P2_HELPER_PO_MID:
    v_add_u32 v14, 122880, v12
    ds_write_b128 v14, v[200:203] offset:0
    ds_write_b128 v14, v[204:207] offset:4096
    ds_write_b128 v14, v[208:211] offset:8192
    ds_write_b128 v14, v[212:215] offset:12288
    ds_write_b128 v14, v[216:219] offset:16384
    ds_write_b128 v14, v[220:223] offset:20480
    s_waitcnt lgkmcnt(0)
    s_cmp_lg_u32 s14, 4
    s_cbranch_scc1 P2_HELPER_PO_DONE
    s_branch P2_HELPER_PO_CHK
P2_HELPER_PO_LOOP:
    buffer_load_dword v25, v24, s[64:67], s40 offen sc1
P2_HELPER_PO_CHK:
    s_add_u32 s44, s44, 1
    s_waitcnt vmcnt(0)
    v_cmp_eq_u32 vcc, v63, v25
    s_cmp_ge_u32 s44, 60000
    s_cbranch_scc1 P2_HELPER_PO_DONE
    s_nop 1
    s_andn2_b32 s45, s42, vcc_lo
    s_cbranch_scc1 P2_HELPER_PO_LOOP
P2_HELPER_PO_DONE:
    s_barrier
    buffer_load_dword v26, v10, s[28:31], 0 offen sc1
    buffer_load_dword v27, v11, s[28:31], 0 offen sc1
    buffer_load_dwordx4 v[16:19], v8, s[16:19], 0 offen
    buffer_load_dwordx4 v[20:23], v9, s[16:19], 0 offen
    v_add_u32 v14, 147456, v12
    ds_write_b128 v14, v[224:227] offset:0
    ds_write_b128 v14, v[228:231] offset:4096
    ds_write_b128 v14, v[232:235] offset:8192
    ds_write_b128 v14, v[236:239] offset:12288
    v_add_u32 v14, 0, v12
    ds_write_b128 v14, v[240:243] offset:0
    ds_write_b128 v14, v[244:247] offset:4096
    ds_write_b128 v14, v[248:251] offset:8192
    ds_write_b128 v14, v[252:255] offset:12288
    s_waitcnt lgkmcnt(0)
    s_waitcnt vmcnt(0)
    v_and_b32 v26, s32, v26
    v_and_b32 v27, s32, v27
    v_rcp_f32 v26, v26
    v_rcp_f32 v27, v27
    v_lshlrev_b32 v32, 16, v16
    v_and_b32 v33, s32, v16
    v_lshlrev_b32 v34, 16, v17
    v_and_b32 v35, s32, v17
    v_lshlrev_b32 v36, 16, v18
    v_and_b32 v37, s32, v18
    v_lshlrev_b32 v38, 16, v19
    v_and_b32 v39, s32, v19
    v_lshlrev_b32 v40, 16, v20
    v_and_b32 v41, s32, v20
    v_lshlrev_b32 v42, 16, v21
    v_and_b32 v43, s32, v21
    v_lshlrev_b32 v44, 16, v22
    v_and_b32 v45, s32, v22
    v_lshlrev_b32 v46, 16, v23
    v_and_b32 v47, s32, v23
    v_mul_f32 v26, v26, v26
    v_mul_f32 v27, v27, v27
    s_barrier
    s_barrier
P2_HFIN:
    s_setprio 0
    ds_read_b128 v[64:67], v13 offset:0
    ds_read_b128 v[68:71], v13 offset:512
    ds_read_b128 v[80:83], v13 offset:8448
    ds_read_b128 v[84:87], v13 offset:8960
    ds_read_b128 v[72:75], v13 offset:128
    ds_read_b128 v[76:79], v13 offset:640
    ds_read_b128 v[88:91], v13 offset:8576
    ds_read_b128 v[92:95], v13 offset:9088
    s_waitcnt lgkmcnt(0)
    v_add_f32 v64, v64, v80
    v_add_f32 v65, v65, v81
    v_add_f32 v66, v66, v82
    v_add_f32 v67, v67, v83
    v_add_f32 v68, v68, v84
    v_add_f32 v69, v69, v85
    v_add_f32 v70, v70, v86
    v_add_f32 v71, v71, v87
    v_add_f32 v72, v72, v88
    v_add_f32 v73, v73, v89
    v_add_f32 v74, v74, v90
    v_add_f32 v75, v75, v91
    v_add_f32 v76, v76, v92
    v_add_f32 v77, v77, v93
    v_add_f32 v78, v78, v94
    v_add_f32 v79, v79, v95
    v_mul_f32 v64, v64, v26
    v_mul_f32 v65, v65, v26
    v_mul_f32 v66, v66, v26
    v_mul_f32 v67, v67, v26
    v_mul_f32 v68, v68, v26
    v_mul_f32 v69, v69, v26
    v_mul_f32 v70, v70, v26
    v_mul_f32 v71, v71, v26
    v_mul_f32 v72, v72, v27
    v_mul_f32 v73, v73, v27
    v_mul_f32 v74, v74, v27
    v_mul_f32 v75, v75, v27
    v_mul_f32 v76, v76, v27
    v_mul_f32 v77, v77, v27
    v_mul_f32 v78, v78, v27
    v_mul_f32 v79, v79, v27
    v_mul_f32 v96, 0xbfb8aa3b, v64
    v_mul_f32 v97, 0xbfb8aa3b, v65
    v_mul_f32 v98, 0xbfb8aa3b, v66
    v_mul_f32 v99, 0xbfb8aa3b, v67
    v_mul_f32 v100, 0xbfb8aa3b, v68
    v_mul_f32 v101, 0xbfb8aa3b, v69
    v_mul_f32 v102, 0xbfb8aa3b, v70
    v_mul_f32 v103, 0xbfb8aa3b, v71
    v_mul_f32 v104, 0xbfb8aa3b, v72
    v_mul_f32 v105, 0xbfb8aa3b, v73
    v_mul_f32 v106, 0xbfb8aa3b, v74
    v_mul_f32 v107, 0xbfb8aa3b, v75
    v_mul_f32 v108, 0xbfb8aa3b, v76
    v_mul_f32 v109, 0xbfb8aa3b, v77
    v_mul_f32 v110, 0xbfb8aa3b, v78
    v_mul_f32 v111, 0xbfb8aa3b, v79
    v_exp_f32 v96, v96
    v_exp_f32 v97, v97
    v_exp_f32 v98, v98
    v_exp_f32 v99, v99
    v_exp_f32 v100, v100
    v_exp_f32 v101, v101
    v_exp_f32 v102, v102
    v_exp_f32 v103, v103
    v_exp_f32 v104, v104
    v_exp_f32 v105, v105
    v_exp_f32 v106, v106
    v_exp_f32 v107, v107
    v_exp_f32 v108, v108
    v_exp_f32 v109, v109
    v_exp_f32 v110, v110
    v_exp_f32 v111, v111
    v_add_f32 v96, 1.0, v96
    v_add_f32 v97, 1.0, v97
    v_add_f32 v98, 1.0, v98
    v_add_f32 v99, 1.0, v99
    v_add_f32 v100, 1.0, v100
    v_add_f32 v101, 1.0, v101
    v_add_f32 v102, 1.0, v102
    v_add_f32 v103, 1.0, v103
    v_add_f32 v104, 1.0, v104
    v_add_f32 v105, 1.0, v105
    v_add_f32 v106, 1.0, v106
    v_add_f32 v107, 1.0, v107
    v_add_f32 v108, 1.0, v108
    v_add_f32 v109, 1.0, v109
    v_add_f32 v110, 1.0, v110
    v_add_f32 v111, 1.0, v111
    v_rcp_f32 v96, v96
    v_rcp_f32 v97, v97
    v_rcp_f32 v98, v98
    v_rcp_f32 v99, v99
    v_rcp_f32 v100, v100
    v_rcp_f32 v101, v101
    v_rcp_f32 v102, v102
    v_rcp_f32 v103, v103
    v_rcp_f32 v104, v104
    v_rcp_f32 v105, v105
    v_rcp_f32 v106, v106
    v_rcp_f32 v107, v107
    v_rcp_f32 v108, v108
    v_rcp_f32 v109, v109
    v_rcp_f32 v110, v110
    v_rcp_f32 v111, v111
    v_mul_f32 v64, v64, v96
    v_mul_f32 v65, v65, v97
    v_mul_f32 v66, v66, v98
    v_mul_f32 v67, v67, v99
    v_mul_f32 v68, v68, v100
    v_mul_f32 v69, v69, v101
    v_mul_f32 v70, v70, v102
    v_mul_f32 v71, v71, v103
    v_mul_f32 v72, v72, v104
    v_mul_f32 v73, v73, v105
    v_mul_f32 v74, v74, v106
    v_mul_f32 v75, v75, v107
    v_mul_f32 v76, v76, v108
    v_mul_f32 v77, v77, v109
    v_mul_f32 v78, v78, v110
    v_mul_f32 v79, v79, v111
    s_barrier
    ds_read_b128 v[80:83], v13 offset:33792
    ds_read_b128 v[84:87], v13 offset:34304
    ds_read_b128 v[96:99], v13 offset:42240
    ds_read_b128 v[100:103], v13 offset:42752
    ds_read_b128 v[88:91], v13 offset:33920
    ds_read_b128 v[92:95], v13 offset:34432
    ds_read_b128 v[104:107], v13 offset:42368
    ds_read_b128 v[108:111], v13 offset:42880
    s_waitcnt lgkmcnt(4)
    v_pk_add_f32 v[80:81], v[80:81], v[96:97]
    v_pk_add_f32 v[82:83], v[82:83], v[98:99]
    v_pk_add_f32 v[84:85], v[84:85], v[100:101]
    v_pk_add_f32 v[86:87], v[86:87], v[102:103]
    v_pk_fma_f32 v[80:81], v[80:81], v[64:65], v[32:33]
    v_pk_fma_f32 v[82:83], v[82:83], v[66:67], v[34:35]
    v_pk_fma_f32 v[84:85], v[84:85], v[68:69], v[36:37]
    v_pk_fma_f32 v[86:87], v[86:87], v[70:71], v[38:39]
    v_cvt_pk_bf16_f32 v128, v80, v81
    v_cvt_pk_bf16_f32 v129, v82, v83
    v_cvt_pk_bf16_f32 v130, v84, v85
    v_cvt_pk_bf16_f32 v131, v86, v87
    buffer_store_dwordx4 v[128:131], v8, s[20:23], 0 offen
    s_waitcnt lgkmcnt(0)
    v_pk_add_f32 v[88:89], v[88:89], v[104:105]
    v_pk_add_f32 v[90:91], v[90:91], v[106:107]
    v_pk_add_f32 v[92:93], v[92:93], v[108:109]
    v_pk_add_f32 v[94:95], v[94:95], v[110:111]
    v_pk_fma_f32 v[88:89], v[88:89], v[72:73], v[40:41]
    v_pk_fma_f32 v[90:91], v[90:91], v[74:75], v[42:43]
    v_pk_fma_f32 v[92:93], v[92:93], v[76:77], v[44:45]
    v_pk_fma_f32 v[94:95], v[94:95], v[78:79], v[46:47]
    v_cvt_pk_bf16_f32 v132, v88, v89
    v_cvt_pk_bf16_f32 v133, v90, v91
    v_cvt_pk_bf16_f32 v134, v92, v93
    v_cvt_pk_bf16_f32 v135, v94, v95
    buffer_store_dwordx4 v[132:135], v9, s[20:23], 0 offen
    s_endpgm
P2_COMPUTE:
    s_barrier
    s_mov_b32 s4, 0
    buffer_load_dwordx4 v[128:131], v3, s[28:31], s4 offen offset:0 sc1
    buffer_load_dwordx4 v[132:135], v3, s[28:31], s4 offen offset:512 sc1
    buffer_load_dwordx4 v[136:139], v3, s[28:31], s4 offen offset:1024 sc1
    buffer_load_dwordx4 v[140:143], v3, s[28:31], s4 offen offset:1536 sc1
    s_mov_b32 s4, 4096
    buffer_load_dwordx4 v[144:147], v3, s[28:31], s4 offen offset:0 sc1
    buffer_load_dwordx4 v[148:151], v3, s[28:31], s4 offen offset:512 sc1
    buffer_load_dwordx4 v[152:155], v3, s[28:31], s4 offen offset:1024 sc1
    buffer_load_dwordx4 v[156:159], v3, s[28:31], s4 offen offset:1536 sc1
    s_mov_b32 s4, 8192
    buffer_load_dwordx4 v[160:163], v3, s[28:31], s4 offen offset:0 sc1
    buffer_load_dwordx4 v[164:167], v3, s[28:31], s4 offen offset:512 sc1
    buffer_load_dwordx4 v[168:171], v3, s[28:31], s4 offen offset:1024 sc1
    buffer_load_dwordx4 v[172:175], v3, s[28:31], s4 offen offset:1536 sc1
    s_mov_b32 s4, 12288
    buffer_load_dwordx4 v[176:179], v3, s[28:31], s4 offen offset:0 sc1
    buffer_load_dwordx4 v[180:183], v3, s[28:31], s4 offen offset:512 sc1
    s_waitcnt vmcnt(12)
    v_mfma_f32_32x32x16_bf16 v[64:79], v[192:195], v[128:131], 0
    buffer_load_dwordx4 v[184:187], v3, s[28:31], s4 offen offset:1024 sc1
    v_mfma_f32_32x32x16_bf16 v[80:95], v[196:199], v[128:131], 0
    buffer_load_dwordx4 v[188:191], v3, s[28:31], s4 offen offset:1536 sc1
    v_mfma_f32_32x32x16_bf16 v[64:79], v[200:203], v[132:135], v[64:79]
    v_mfma_f32_32x32x16_bf16 v[80:95], v[204:207], v[132:135], v[80:95]
    s_waitcnt vmcnt(12)
    v_mfma_f32_32x32x16_bf16 v[64:79], v[208:211], v[136:139], v[64:79]
    s_mov_b32 s4, 16384
    v_mfma_f32_32x32x16_bf16 v[80:95], v[212:215], v[136:139], v[80:95]
    buffer_load_dwordx4 v[128:131], v3, s[28:31], s4 offen offset:0 sc1
    v_mfma_f32_32x32x16_bf16 v[64:79], v[216:219], v[140:143], v[64:79]
    buffer_load_dwordx4 v[132:135], v3, s[28:31], s4 offen offset:512 sc1
    v_mfma_f32_32x32x16_bf16 v[80:95], v[220:223], v[140:143], v[80:95]
    s_waitcnt vmcnt(12)
    v_mfma_f32_32x32x16_bf16 v[64:79], v[224:227], v[144:147], v[64:79]
    buffer_load_dwordx4 v[136:139], v3, s[28:31], s4 offen offset:1024 sc1
    v_mfma_f32_32x32x16_bf16 v[80:95], v[228:231], v[144:147], v[80:95]
    buffer_load_dwordx4 v[140:143], v3, s[28:31], s4 offen offset:1536 sc1
    v_mfma_f32_32x32x16_bf16 v[64:79], v[232:235], v[148:151], v[64:79]
    v_mfma_f32_32x32x16_bf16 v[80:95], v[236:239], v[148:151], v[80:95]
    s_waitcnt vmcnt(12)
    v_mfma_f32_32x32x16_bf16 v[64:79], v[240:243], v[152:155], v[64:79]
    s_mov_b32 s4, 20480
    v_mfma_f32_32x32x16_bf16 v[80:95], v[244:247], v[152:155], v[80:95]
    buffer_load_dwordx4 v[144:147], v3, s[28:31], s4 offen offset:0 sc1
    v_mfma_f32_32x32x16_bf16 v[64:79], v[248:251], v[156:159], v[64:79]
    buffer_load_dwordx4 v[148:151], v3, s[28:31], s4 offen offset:512 sc1
    v_mfma_f32_32x32x16_bf16 v[80:95], v[252:255], v[156:159], v[80:95]
    s_waitcnt vmcnt(12)
    v_mfma_f32_32x32x16_bf16 v[64:79], v[96:99], v[160:163], v[64:79]
    buffer_load_dwordx4 v[152:155], v3, s[28:31], s4 offen offset:1024 sc1
    v_mfma_f32_32x32x16_bf16 v[80:95], v[100:103], v[160:163], v[80:95]
    buffer_load_dwordx4 v[156:159], v3, s[28:31], s4 offen offset:1536 sc1
    v_mfma_f32_32x32x16_bf16 v[64:79], v[104:107], v[164:167], v[64:79]
    v_mfma_f32_32x32x16_bf16 v[80:95], v[108:111], v[164:167], v[80:95]
    s_waitcnt vmcnt(12)
    v_mfma_f32_32x32x16_bf16 v[64:79], v[112:115], v[168:171], v[64:79]
    s_mov_b32 s4, 24576
    v_mfma_f32_32x32x16_bf16 v[80:95], v[116:119], v[168:171], v[80:95]
    buffer_load_dwordx4 v[160:163], v3, s[28:31], s4 offen offset:0 sc1
    v_mfma_f32_32x32x16_bf16 v[64:79], v[120:123], v[172:175], v[64:79]
    buffer_load_dwordx4 v[164:167], v3, s[28:31], s4 offen offset:512 sc1
    v_mfma_f32_32x32x16_bf16 v[80:95], v[124:127], v[172:175], v[80:95]
    s_waitcnt vmcnt(12)
    v_mfma_f32_32x32x16_bf16 v[64:79], v[16:19], v[176:179], v[64:79]
    v_add_u32 v7, 114688, v5
    v_add_u32 v8, 114688, v6
    ds_read_b64_tr_b16 v[48:49], v7 offset:0
    buffer_load_dwordx4 v[168:171], v3, s[28:31], s4 offen offset:1024 sc1
    v_mfma_f32_32x32x16_bf16 v[80:95], v[20:23], v[176:179], v[80:95]
    ds_read_b64_tr_b16 v[50:51], v7 offset:2048
    ds_read_b64_tr_b16 v[52:53], v8 offset:0
    ds_read_b64_tr_b16 v[54:55], v8 offset:2048
    buffer_load_dwordx4 v[172:175], v3, s[28:31], s4 offen offset:1536 sc1
    v_mfma_f32_32x32x16_bf16 v[64:79], v[24:27], v[180:183], v[64:79]
    ds_read_b64_tr_b16 v[56:57], v7 offset:1024
    ds_read_b64_tr_b16 v[58:59], v7 offset:3072
    v_mfma_f32_32x32x16_bf16 v[80:95], v[28:31], v[180:183], v[80:95]
    ds_read_b64_tr_b16 v[60:61], v8 offset:1024
    ds_read_b64_tr_b16 v[62:63], v8 offset:3072
    s_waitcnt vmcnt(12)
    v_mfma_f32_32x32x16_bf16 v[64:79], v[32:35], v[184:187], v[64:79]
    v_mfma_f32_32x32x16_bf16 v[80:95], v[36:39], v[184:187], v[80:95]
    s_waitcnt lgkmcnt(0)
    s_barrier
    ds_read_b64_tr_b16 v[16:17], v7 offset:8192
    ds_read_b64_tr_b16 v[18:19], v7 offset:10240
    ds_read_b64_tr_b16 v[20:21], v8 offset:8192
    s_mov_b32 s4, 28672
    v_mfma_f32_32x32x16_bf16 v[64:79], v[40:43], v[188:191], v[64:79]
    ds_read_b64_tr_b16 v[22:23], v8 offset:10240
    ds_read_b64_tr_b16 v[24:25], v7 offset:9216
    ds_read_b64_tr_b16 v[26:27], v7 offset:11264
    buffer_load_dwordx4 v[176:179], v3, s[28:31], s4 offen offset:0 sc1
    v_mfma_f32_32x32x16_bf16 v[80:95], v[44:47], v[188:191], v[80:95]
    ds_read_b64_tr_b16 v[28:29], v8 offset:9216
    ds_read_b64_tr_b16 v[30:31], v8 offset:11264
    buffer_load_dwordx4 v[180:183], v3, s[28:31], s4 offen offset:512 sc1
    s_waitcnt vmcnt(12)
    v_mfma_f32_32x32x16_bf16 v[64:79], v[48:51], v[128:131], v[64:79]
    ds_read_b64_tr_b16 v[32:33], v7 offset:16384
    ds_read_b64_tr_b16 v[34:35], v7 offset:18432
    buffer_load_dwordx4 v[184:187], v3, s[28:31], s4 offen offset:1024 sc1
    v_mfma_f32_32x32x16_bf16 v[80:95], v[52:55], v[128:131], v[80:95]
    ds_read_b64_tr_b16 v[36:37], v8 offset:16384
    ds_read_b64_tr_b16 v[38:39], v8 offset:18432
    buffer_load_dwordx4 v[188:191], v3, s[28:31], s4 offen offset:1536 sc1
    v_mfma_f32_32x32x16_bf16 v[64:79], v[56:59], v[132:135], v[64:79]
    ds_read_b64_tr_b16 v[40:41], v7 offset:17408
    ds_read_b64_tr_b16 v[42:43], v7 offset:19456
    v_mfma_f32_32x32x16_bf16 v[80:95], v[60:63], v[132:135], v[80:95]
    ds_read_b64_tr_b16 v[44:45], v8 offset:17408
    ds_read_b64_tr_b16 v[46:47], v8 offset:19456
    s_waitcnt lgkmcnt(8)
    s_waitcnt vmcnt(12)
    v_mfma_f32_32x32x16_bf16 v[64:79], v[16:19], v[136:139], v[64:79]
    ds_read_b64_tr_b16 v[48:49], v7 offset:24576
    ds_read_b64_tr_b16 v[50:51], v7 offset:26624
    s_mov_b32 s4, 32768
    v_mfma_f32_32x32x16_bf16 v[80:95], v[20:23], v[136:139], v[80:95]
    ds_read_b64_tr_b16 v[52:53], v8 offset:24576
    ds_read_b64_tr_b16 v[54:55], v8 offset:26624
    buffer_load_dwordx4 v[128:131], v3, s[28:31], s4 offen offset:0 sc1
    v_mfma_f32_32x32x16_bf16 v[64:79], v[24:27], v[140:143], v[64:79]
    ds_read_b64_tr_b16 v[56:57], v7 offset:25600
    ds_read_b64_tr_b16 v[58:59], v7 offset:27648
    buffer_load_dwordx4 v[132:135], v3, s[28:31], s4 offen offset:512 sc1
    v_mfma_f32_32x32x16_bf16 v[80:95], v[28:31], v[140:143], v[80:95]
    ds_read_b64_tr_b16 v[60:61], v8 offset:25600
    ds_read_b64_tr_b16 v[62:63], v8 offset:27648
    s_waitcnt lgkmcnt(8)
    s_waitcnt vmcnt(12)
    v_mfma_f32_32x32x16_bf16 v[64:79], v[32:35], v[144:147], v[64:79]
    ds_read_b64_tr_b16 v[16:17], v7 offset:32768
    ds_read_b64_tr_b16 v[18:19], v7 offset:34816
    buffer_load_dwordx4 v[136:139], v3, s[28:31], s4 offen offset:1024 sc1
    v_mfma_f32_32x32x16_bf16 v[80:95], v[36:39], v[144:147], v[80:95]
    ds_read_b64_tr_b16 v[20:21], v8 offset:32768
    ds_read_b64_tr_b16 v[22:23], v8 offset:34816
    buffer_load_dwordx4 v[140:143], v3, s[28:31], s4 offen offset:1536 sc1
    v_mfma_f32_32x32x16_bf16 v[64:79], v[40:43], v[148:151], v[64:79]
    ds_read_b64_tr_b16 v[24:25], v7 offset:33792
    ds_read_b64_tr_b16 v[26:27], v7 offset:35840
    v_mfma_f32_32x32x16_bf16 v[80:95], v[44:47], v[148:151], v[80:95]
    ds_read_b64_tr_b16 v[28:29], v8 offset:33792
    ds_read_b64_tr_b16 v[30:31], v8 offset:35840
    s_waitcnt lgkmcnt(8)
    s_waitcnt vmcnt(12)
    v_mfma_f32_32x32x16_bf16 v[64:79], v[48:51], v[152:155], v[64:79]
    ds_read_b64_tr_b16 v[32:33], v7 offset:40960
    ds_read_b64_tr_b16 v[34:35], v7 offset:43008
    s_mov_b32 s4, 36864
    v_mfma_f32_32x32x16_bf16 v[80:95], v[52:55], v[152:155], v[80:95]
    ds_read_b64_tr_b16 v[36:37], v8 offset:40960
    ds_read_b64_tr_b16 v[38:39], v8 offset:43008
    buffer_load_dwordx4 v[144:147], v3, s[28:31], s4 offen offset:0 sc1
    v_mfma_f32_32x32x16_bf16 v[64:79], v[56:59], v[156:159], v[64:79]
    ds_read_b64_tr_b16 v[40:41], v7 offset:41984
    ds_read_b64_tr_b16 v[42:43], v7 offset:44032
    buffer_load_dwordx4 v[148:151], v3, s[28:31], s4 offen offset:512 sc1
    v_mfma_f32_32x32x16_bf16 v[80:95], v[60:63], v[156:159], v[80:95]
    ds_read_b64_tr_b16 v[44:45], v8 offset:41984
    ds_read_b64_tr_b16 v[46:47], v8 offset:44032
    s_waitcnt lgkmcnt(8)
    s_waitcnt vmcnt(12)
    v_mfma_f32_32x32x16_bf16 v[64:79], v[16:19], v[160:163], v[64:79]
    v_mfma_f32_32x32x16_bf16 v[80:95], v[20:23], v[160:163], v[80:95]
    s_waitcnt lgkmcnt(0)
    s_barrier
    v_add_u32 v7, 0, v5
    v_add_u32 v8, 0, v6
    ds_read_b64_tr_b16 v[48:49], v7 offset:0
    ds_read_b64_tr_b16 v[50:51], v7 offset:2048
    buffer_load_dwordx4 v[152:155], v3, s[28:31], s4 offen offset:1024 sc1
    v_mfma_f32_32x32x16_bf16 v[64:79], v[24:27], v[164:167], v[64:79]
    ds_read_b64_tr_b16 v[52:53], v8 offset:0
    ds_read_b64_tr_b16 v[54:55], v8 offset:2048
    ds_read_b64_tr_b16 v[56:57], v7 offset:1024
    buffer_load_dwordx4 v[156:159], v3, s[28:31], s4 offen offset:1536 sc1
    v_mfma_f32_32x32x16_bf16 v[80:95], v[28:31], v[164:167], v[80:95]
    ds_read_b64_tr_b16 v[58:59], v7 offset:3072
    ds_read_b64_tr_b16 v[60:61], v8 offset:1024
    ds_read_b64_tr_b16 v[62:63], v8 offset:3072
    s_waitcnt vmcnt(12)
    v_mfma_f32_32x32x16_bf16 v[64:79], v[32:35], v[168:171], v[64:79]
    ds_read_b64_tr_b16 v[16:17], v7 offset:8192
    ds_read_b64_tr_b16 v[18:19], v7 offset:10240
    s_mov_b32 s4, 40960
    v_mfma_f32_32x32x16_bf16 v[80:95], v[36:39], v[168:171], v[80:95]
    ds_read_b64_tr_b16 v[20:21], v8 offset:8192
    ds_read_b64_tr_b16 v[22:23], v8 offset:10240
    buffer_load_dwordx4 v[160:163], v3, s[28:31], s4 offen offset:0 sc1
    v_mfma_f32_32x32x16_bf16 v[64:79], v[40:43], v[172:175], v[64:79]
    ds_read_b64_tr_b16 v[24:25], v7 offset:9216
    ds_read_b64_tr_b16 v[26:27], v7 offset:11264
    buffer_load_dwordx4 v[164:167], v3, s[28:31], s4 offen offset:512 sc1
    v_mfma_f32_32x32x16_bf16 v[80:95], v[44:47], v[172:175], v[80:95]
    ds_read_b64_tr_b16 v[28:29], v8 offset:9216
    ds_read_b64_tr_b16 v[30:31], v8 offset:11264
    s_waitcnt lgkmcnt(8)
    s_waitcnt vmcnt(12)
    v_mfma_f32_32x32x16_bf16 v[64:79], v[48:51], v[176:179], v[64:79]
    ds_read_b64_tr_b16 v[32:33], v7 offset:16384
    ds_read_b64_tr_b16 v[34:35], v7 offset:18432
    buffer_load_dwordx4 v[168:171], v3, s[28:31], s4 offen offset:1024 sc1
    v_mfma_f32_32x32x16_bf16 v[80:95], v[52:55], v[176:179], v[80:95]
    ds_read_b64_tr_b16 v[36:37], v8 offset:16384
    ds_read_b64_tr_b16 v[38:39], v8 offset:18432
    buffer_load_dwordx4 v[172:175], v3, s[28:31], s4 offen offset:1536 sc1
    v_mfma_f32_32x32x16_bf16 v[64:79], v[56:59], v[180:183], v[64:79]
    ds_read_b64_tr_b16 v[40:41], v7 offset:17408
    ds_read_b64_tr_b16 v[42:43], v7 offset:19456
    v_mfma_f32_32x32x16_bf16 v[80:95], v[60:63], v[180:183], v[80:95]
    ds_read_b64_tr_b16 v[44:45], v8 offset:17408
    ds_read_b64_tr_b16 v[46:47], v8 offset:19456
    s_waitcnt lgkmcnt(8)
    s_waitcnt vmcnt(12)
    v_mfma_f32_32x32x16_bf16 v[64:79], v[16:19], v[184:187], v[64:79]
    ds_read_b64_tr_b16 v[48:49], v7 offset:24576
    ds_read_b64_tr_b16 v[50:51], v7 offset:26624
    s_mov_b32 s4, 45056
    v_mfma_f32_32x32x16_bf16 v[80:95], v[20:23], v[184:187], v[80:95]
    ds_read_b64_tr_b16 v[52:53], v8 offset:24576
    ds_read_b64_tr_b16 v[54:55], v8 offset:26624
    buffer_load_dwordx4 v[176:179], v3, s[28:31], s4 offen offset:0 sc1
    v_mfma_f32_32x32x16_bf16 v[64:79], v[24:27], v[188:191], v[64:79]
    ds_read_b64_tr_b16 v[56:57], v7 offset:25600
    ds_read_b64_tr_b16 v[58:59], v7 offset:27648
    buffer_load_dwordx4 v[180:183], v3, s[28:31], s4 offen offset:512 sc1
    v_mfma_f32_32x32x16_bf16 v[80:95], v[28:31], v[188:191], v[80:95]
    ds_read_b64_tr_b16 v[60:61], v8 offset:25600
    ds_read_b64_tr_b16 v[62:63], v8 offset:27648
    s_waitcnt lgkmcnt(8)
    s_waitcnt vmcnt(12)
    v_mfma_f32_32x32x16_bf16 v[64:79], v[32:35], v[128:131], v[64:79]
    ds_read_b64_tr_b16 v[16:17], v7 offset:32768
    ds_read_b64_tr_b16 v[18:19], v7 offset:34816
    buffer_load_dwordx4 v[184:187], v3, s[28:31], s4 offen offset:1024 sc1
    v_mfma_f32_32x32x16_bf16 v[80:95], v[36:39], v[128:131], v[80:95]
    ds_read_b64_tr_b16 v[20:21], v8 offset:32768
    ds_read_b64_tr_b16 v[22:23], v8 offset:34816
    buffer_load_dwordx4 v[188:191], v3, s[28:31], s4 offen offset:1536 sc1
    v_mfma_f32_32x32x16_bf16 v[64:79], v[40:43], v[132:135], v[64:79]
    ds_read_b64_tr_b16 v[24:25], v7 offset:33792
    ds_read_b64_tr_b16 v[26:27], v7 offset:35840
    v_mfma_f32_32x32x16_bf16 v[80:95], v[44:47], v[132:135], v[80:95]
    ds_read_b64_tr_b16 v[28:29], v8 offset:33792
    ds_read_b64_tr_b16 v[30:31], v8 offset:35840
    s_waitcnt lgkmcnt(8)
    s_waitcnt vmcnt(12)
    v_mfma_f32_32x32x16_bf16 v[64:79], v[48:51], v[136:139], v[64:79]
    ds_read_b64_tr_b16 v[32:33], v7 offset:40960
    ds_read_b64_tr_b16 v[34:35], v7 offset:43008
    s_mov_b32 s4, 49152
    v_mfma_f32_32x32x16_bf16 v[80:95], v[52:55], v[136:139], v[80:95]
    ds_read_b64_tr_b16 v[36:37], v8 offset:40960
    ds_read_b64_tr_b16 v[38:39], v8 offset:43008
    buffer_load_dwordx4 v[128:131], v3, s[28:31], s4 offen offset:0 sc1
    v_mfma_f32_32x32x16_bf16 v[64:79], v[56:59], v[140:143], v[64:79]
    ds_read_b64_tr_b16 v[40:41], v7 offset:41984
    ds_read_b64_tr_b16 v[42:43], v7 offset:44032
    buffer_load_dwordx4 v[132:135], v3, s[28:31], s4 offen offset:512 sc1
    v_mfma_f32_32x32x16_bf16 v[80:95], v[60:63], v[140:143], v[80:95]
    ds_read_b64_tr_b16 v[44:45], v8 offset:41984
    ds_read_b64_tr_b16 v[46:47], v8 offset:44032
    s_waitcnt lgkmcnt(8)
    s_waitcnt vmcnt(12)
    v_mfma_f32_32x32x16_bf16 v[64:79], v[16:19], v[144:147], v[64:79]
    v_mfma_f32_32x32x16_bf16 v[80:95], v[20:23], v[144:147], v[80:95]
    s_waitcnt lgkmcnt(0)
    s_barrier
    ds_read_b64_tr_b16 v[48:49], v7 offset:49152
    ds_read_b64_tr_b16 v[50:51], v7 offset:51200
    ds_read_b64_tr_b16 v[52:53], v8 offset:49152
    buffer_load_dwordx4 v[136:139], v3, s[28:31], s4 offen offset:1024 sc1
    v_mfma_f32_32x32x16_bf16 v[64:79], v[24:27], v[148:151], v[64:79]
    ds_read_b64_tr_b16 v[54:55], v8 offset:51200
    ds_read_b64_tr_b16 v[56:57], v7 offset:50176
    ds_read_b64_tr_b16 v[58:59], v7 offset:52224
    buffer_load_dwordx4 v[140:143], v3, s[28:31], s4 offen offset:1536 sc1
    v_mfma_f32_32x32x16_bf16 v[80:95], v[28:31], v[148:151], v[80:95]
    ds_read_b64_tr_b16 v[60:61], v8 offset:50176
    ds_read_b64_tr_b16 v[62:63], v8 offset:52224
    s_waitcnt vmcnt(12)
    v_mfma_f32_32x32x16_bf16 v[64:79], v[32:35], v[152:155], v[64:79]
    ds_read_b64_tr_b16 v[16:17], v7 offset:57344
    ds_read_b64_tr_b16 v[18:19], v7 offset:59392
    s_mov_b32 s4, 53248
    v_mfma_f32_32x32x16_bf16 v[80:95], v[36:39], v[152:155], v[80:95]
    ds_read_b64_tr_b16 v[20:21], v8 offset:57344
    ds_read_b64_tr_b16 v[22:23], v8 offset:59392
    buffer_load_dwordx4 v[144:147], v3, s[28:31], s4 offen offset:0 sc1
    v_mfma_f32_32x32x16_bf16 v[64:79], v[40:43], v[156:159], v[64:79]
    ds_read_b64_tr_b16 v[24:25], v7 offset:58368
    ds_read_b64_tr_b16 v[26:27], v7 offset:60416
    buffer_load_dwordx4 v[148:151], v3, s[28:31], s4 offen offset:512 sc1
    v_mfma_f32_32x32x16_bf16 v[80:95], v[44:47], v[156:159], v[80:95]
    ds_read_b64_tr_b16 v[28:29], v8 offset:58368
    ds_read_b64_tr_b16 v[30:31], v8 offset:60416
    s_waitcnt lgkmcnt(8)
    s_waitcnt vmcnt(12)
    v_mfma_f32_32x32x16_bf16 v[64:79], v[48:51], v[160:163], v[64:79]
    v_add_u32 v7, 65536, v5
    v_add_u32 v8, 65536, v6
    ds_read_b64_tr_b16 v[32:33], v7 offset:0
    buffer_load_dwordx4 v[152:155], v3, s[28:31], s4 offen offset:1024 sc1
    v_mfma_f32_32x32x16_bf16 v[80:95], v[52:55], v[160:163], v[80:95]
    ds_read_b64_tr_b16 v[34:35], v7 offset:2048
    ds_read_b64_tr_b16 v[36:37], v8 offset:0
    ds_read_b64_tr_b16 v[38:39], v8 offset:2048
    buffer_load_dwordx4 v[156:159], v3, s[28:31], s4 offen offset:1536 sc1
    v_mfma_f32_32x32x16_bf16 v[64:79], v[56:59], v[164:167], v[64:79]
    ds_read_b64_tr_b16 v[40:41], v7 offset:1024
    ds_read_b64_tr_b16 v[42:43], v7 offset:3072
    v_mfma_f32_32x32x16_bf16 v[80:95], v[60:63], v[164:167], v[80:95]
    ds_read_b64_tr_b16 v[44:45], v8 offset:1024
    ds_read_b64_tr_b16 v[46:47], v8 offset:3072
    s_waitcnt lgkmcnt(8)
    s_waitcnt vmcnt(12)
    v_mfma_f32_32x32x16_bf16 v[64:79], v[16:19], v[168:171], v[64:79]
    ds_read_b64_tr_b16 v[48:49], v7 offset:8192
    ds_read_b64_tr_b16 v[50:51], v7 offset:10240
    s_mov_b32 s4, 0
    v_mfma_f32_32x32x16_bf16 v[80:95], v[20:23], v[168:171], v[80:95]
    ds_read_b64_tr_b16 v[52:53], v8 offset:8192
    ds_read_b64_tr_b16 v[54:55], v8 offset:10240
    buffer_load_dwordx4 v[160:163], v4, s[28:31], s4 offen offset:0 sc1
    v_mfma_f32_32x32x16_bf16 v[64:79], v[24:27], v[172:175], v[64:79]
    ds_read_b64_tr_b16 v[56:57], v7 offset:9216
    ds_read_b64_tr_b16 v[58:59], v7 offset:11264
    buffer_load_dwordx4 v[164:167], v4, s[28:31], s4 offen offset:512 sc1
    v_mfma_f32_32x32x16_bf16 v[80:95], v[28:31], v[172:175], v[80:95]
    ds_read_b64_tr_b16 v[60:61], v8 offset:9216
    ds_read_b64_tr_b16 v[62:63], v8 offset:11264
    s_waitcnt lgkmcnt(8)
    s_waitcnt vmcnt(12)
    v_mfma_f32_32x32x16_bf16 v[64:79], v[32:35], v[176:179], v[64:79]
    ds_read_b64_tr_b16 v[16:17], v7 offset:16384
    ds_read_b64_tr_b16 v[18:19], v7 offset:18432
    buffer_load_dwordx4 v[168:171], v4, s[28:31], s4 offen offset:1024 sc1
    v_mfma_f32_32x32x16_bf16 v[80:95], v[36:39], v[176:179], v[80:95]
    ds_read_b64_tr_b16 v[20:21], v8 offset:16384
    ds_read_b64_tr_b16 v[22:23], v8 offset:18432
    buffer_load_dwordx4 v[172:175], v4, s[28:31], s4 offen offset:1536 sc1
    v_mfma_f32_32x32x16_bf16 v[64:79], v[40:43], v[180:183], v[64:79]
    ds_read_b64_tr_b16 v[24:25], v7 offset:17408
    ds_read_b64_tr_b16 v[26:27], v7 offset:19456
    v_mfma_f32_32x32x16_bf16 v[80:95], v[44:47], v[180:183], v[80:95]
    ds_read_b64_tr_b16 v[28:29], v8 offset:17408
    ds_read_b64_tr_b16 v[30:31], v8 offset:19456
    s_waitcnt lgkmcnt(8)
    s_waitcnt vmcnt(12)
    v_mfma_f32_32x32x16_bf16 v[64:79], v[48:51], v[184:187], v[64:79]
    ds_read_b64_tr_b16 v[32:33], v7 offset:24576
    ds_read_b64_tr_b16 v[34:35], v7 offset:26624
    buffer_load_dwordx4 v[176:179], v4, s[28:31], s4 offen offset:2048 sc1
    v_mfma_f32_32x32x16_bf16 v[80:95], v[52:55], v[184:187], v[80:95]
    ds_read_b64_tr_b16 v[36:37], v8 offset:24576
    ds_read_b64_tr_b16 v[38:39], v8 offset:26624
    buffer_load_dwordx4 v[180:183], v4, s[28:31], s4 offen offset:2560 sc1
    v_mfma_f32_32x32x16_bf16 v[64:79], v[56:59], v[188:191], v[64:79]
    ds_read_b64_tr_b16 v[40:41], v7 offset:25600
    ds_read_b64_tr_b16 v[42:43], v7 offset:27648
    v_mfma_f32_32x32x16_bf16 v[80:95], v[60:63], v[188:191], v[80:95]
    ds_read_b64_tr_b16 v[44:45], v8 offset:25600
    ds_read_b64_tr_b16 v[46:47], v8 offset:27648
    s_waitcnt lgkmcnt(8)
    s_waitcnt vmcnt(12)
    v_mfma_f32_32x32x16_bf16 v[64:79], v[16:19], v[128:131], v[64:79]
    ds_read_b64_tr_b16 v[48:49], v7 offset:32768
    ds_read_b64_tr_b16 v[50:51], v7 offset:34816
    buffer_load_dwordx4 v[184:187], v4, s[28:31], s4 offen offset:3072 sc1
    v_mfma_f32_32x32x16_bf16 v[80:95], v[20:23], v[128:131], v[80:95]
    ds_read_b64_tr_b16 v[52:53], v8 offset:32768
    ds_read_b64_tr_b16 v[54:55], v8 offset:34816
    buffer_load_dwordx4 v[188:191], v4, s[28:31], s4 offen offset:3584 sc1
    v_mfma_f32_32x32x16_bf16 v[64:79], v[24:27], v[132:135], v[64:79]
    ds_read_b64_tr_b16 v[56:57], v7 offset:33792
    ds_read_b64_tr_b16 v[58:59], v7 offset:35840
    v_mfma_f32_32x32x16_bf16 v[80:95], v[28:31], v[132:135], v[80:95]
    ds_read_b64_tr_b16 v[60:61], v8 offset:33792
    ds_read_b64_tr_b16 v[62:63], v8 offset:35840
    s_waitcnt lgkmcnt(8)
    s_waitcnt vmcnt(12)
    v_mfma_f32_32x32x16_bf16 v[64:79], v[32:35], v[136:139], v[64:79]
    ds_read_b64_tr_b16 v[16:17], v7 offset:40960
    ds_read_b64_tr_b16 v[18:19], v7 offset:43008
    s_mov_b32 s4, 4096
    v_mfma_f32_32x32x16_bf16 v[80:95], v[36:39], v[136:139], v[80:95]
    ds_read_b64_tr_b16 v[20:21], v8 offset:40960
    ds_read_b64_tr_b16 v[22:23], v8 offset:43008
    buffer_load_dwordx4 v[128:131], v4, s[28:31], s4 offen offset:0 sc1
    v_mfma_f32_32x32x16_bf16 v[64:79], v[40:43], v[140:143], v[64:79]
    ds_read_b64_tr_b16 v[24:25], v7 offset:41984
    ds_read_b64_tr_b16 v[26:27], v7 offset:44032
    buffer_load_dwordx4 v[132:135], v4, s[28:31], s4 offen offset:512 sc1
    v_mfma_f32_32x32x16_bf16 v[80:95], v[44:47], v[140:143], v[80:95]
    ds_read_b64_tr_b16 v[28:29], v8 offset:41984
    ds_read_b64_tr_b16 v[30:31], v8 offset:44032
    s_waitcnt lgkmcnt(8)
    s_waitcnt vmcnt(12)
    v_mfma_f32_32x32x16_bf16 v[64:79], v[48:51], v[144:147], v[64:79]
    v_mfma_f32_32x32x16_bf16 v[80:95], v[52:55], v[144:147], v[80:95]
    s_waitcnt lgkmcnt(0)
    s_barrier
    ds_read_b64_tr_b16 v[32:33], v7 offset:49152
    ds_read_b64_tr_b16 v[34:35], v7 offset:51200
    ds_read_b64_tr_b16 v[36:37], v8 offset:49152
    buffer_load_dwordx4 v[136:139], v4, s[28:31], s4 offen offset:1024 sc1
    v_mfma_f32_32x32x16_bf16 v[64:79], v[56:59], v[148:151], v[64:79]
    ds_read_b64_tr_b16 v[38:39], v8 offset:51200
    ds_read_b64_tr_b16 v[40:41], v7 offset:50176
    ds_read_b64_tr_b16 v[42:43], v7 offset:52224
    buffer_load_dwordx4 v[140:143], v4, s[28:31], s4 offen offset:1536 sc1
    v_mfma_f32_32x32x16_bf16 v[80:95], v[60:63], v[148:151], v[80:95]
    ds_read_b64_tr_b16 v[44:45], v8 offset:50176
    ds_read_b64_tr_b16 v[46:47], v8 offset:52224
    s_waitcnt vmcnt(12)
    v_mfma_f32_32x32x16_bf16 v[64:79], v[16:19], v[152:155], v[64:79]
    ds_read_b64_tr_b16 v[48:49], v7 offset:57344
    ds_read_b64_tr_b16 v[50:51], v7 offset:59392
    buffer_load_dwordx4 v[144:147], v4, s[28:31], s4 offen offset:2048 sc1
    v_mfma_f32_32x32x16_bf16 v[80:95], v[20:23], v[152:155], v[80:95]
    ds_read_b64_tr_b16 v[52:53], v8 offset:57344
    ds_read_b64_tr_b16 v[54:55], v8 offset:59392
    buffer_load_dwordx4 v[148:151], v4, s[28:31], s4 offen offset:2560 sc1
    v_mfma_f32_32x32x16_bf16 v[64:79], v[24:27], v[156:159], v[64:79]
    ds_read_b64_tr_b16 v[56:57], v7 offset:58368
    ds_read_b64_tr_b16 v[58:59], v7 offset:60416
    v_mfma_f32_32x32x16_bf16 v[80:95], v[28:31], v[156:159], v[80:95]
    ds_read_b64_tr_b16 v[60:61], v8 offset:58368
    ds_read_b64_tr_b16 v[62:63], v8 offset:60416
    s_waitcnt lgkmcnt(8)
    s_waitcnt vmcnt(12)
    v_mfma_f32_32x32x16_bf16 v[96:111], v[32:35], v[160:163], 0
    v_add_u32 v7, 131072, v5
    v_add_u32 v8, 131072, v6
    ds_read_b64_tr_b16 v[16:17], v7 offset:0
    buffer_load_dwordx4 v[152:155], v4, s[28:31], s4 offen offset:3072 sc1
    v_mfma_f32_32x32x16_bf16 v[112:127], v[36:39], v[160:163], 0
    ds_read_b64_tr_b16 v[18:19], v7 offset:2048
    ds_read_b64_tr_b16 v[20:21], v8 offset:0
    ds_read_b64_tr_b16 v[22:23], v8 offset:2048
    buffer_load_dwordx4 v[156:159], v4, s[28:31], s4 offen offset:3584 sc1
    v_mfma_f32_32x32x16_bf16 v[96:111], v[40:43], v[164:167], v[96:111]
    ds_read_b64_tr_b16 v[24:25], v7 offset:1024
    ds_read_b64_tr_b16 v[26:27], v7 offset:3072
    ds_write_b128 v9, v[64:67] offset:0
    ds_write_b128 v9, v[68:71] offset:1056
    ds_write_b128 v9, v[72:75] offset:2112
    ds_write_b128 v9, v[76:79] offset:3168
    v_mfma_f32_32x32x16_bf16 v[112:127], v[44:47], v[164:167], v[112:127]
    ds_read_b64_tr_b16 v[28:29], v8 offset:1024
    ds_read_b64_tr_b16 v[30:31], v8 offset:3072
    ds_write_b128 v9, v[80:83] offset:4224
    ds_write_b128 v9, v[84:87] offset:5280
    ds_write_b128 v9, v[88:91] offset:6336
    ds_write_b128 v9, v[92:95] offset:7392
    s_waitcnt lgkmcnt(14)
    s_waitcnt vmcnt(12)
    v_mfma_f32_32x32x16_bf16 v[96:111], v[48:51], v[168:171], v[96:111]
    v_mfma_f32_32x32x16_bf16 v[112:127], v[52:55], v[168:171], v[112:127]
    s_waitcnt lgkmcnt(0)
    s_barrier
    ds_read_b64_tr_b16 v[32:33], v7 offset:8192
    ds_read_b64_tr_b16 v[34:35], v7 offset:10240
    ds_read_b64_tr_b16 v[36:37], v8 offset:8192
    v_mfma_f32_32x32x16_bf16 v[96:111], v[56:59], v[172:175], v[96:111]
    ds_read_b64_tr_b16 v[38:39], v8 offset:10240
    ds_read_b64_tr_b16 v[40:41], v7 offset:9216
    ds_read_b64_tr_b16 v[42:43], v7 offset:11264
    v_mfma_f32_32x32x16_bf16 v[112:127], v[60:63], v[172:175], v[112:127]
    ds_read_b64_tr_b16 v[44:45], v8 offset:9216
    ds_read_b64_tr_b16 v[46:47], v8 offset:11264
    s_waitcnt vmcnt(10)
    v_mfma_f32_32x32x16_bf16 v[96:111], v[16:19], v[176:179], v[96:111]
    ds_read_b64_tr_b16 v[48:49], v7 offset:16384
    ds_read_b64_tr_b16 v[50:51], v7 offset:18432
    v_mfma_f32_32x32x16_bf16 v[112:127], v[20:23], v[176:179], v[112:127]
    ds_read_b64_tr_b16 v[52:53], v8 offset:16384
    ds_read_b64_tr_b16 v[54:55], v8 offset:18432
    v_mfma_f32_32x32x16_bf16 v[96:111], v[24:27], v[180:183], v[96:111]
    ds_read_b64_tr_b16 v[56:57], v7 offset:17408
    ds_read_b64_tr_b16 v[58:59], v7 offset:19456
    v_mfma_f32_32x32x16_bf16 v[112:127], v[28:31], v[180:183], v[112:127]
    ds_read_b64_tr_b16 v[60:61], v8 offset:17408
    ds_read_b64_tr_b16 v[62:63], v8 offset:19456
    s_waitcnt lgkmcnt(8)
    s_waitcnt vmcnt(8)
    v_mfma_f32_32x32x16_bf16 v[96:111], v[32:35], v[184:187], v[96:111]
    ds_read_b64_tr_b16 v[16:17], v7 offset:24576
    ds_read_b64_tr_b16 v[18:19], v7 offset:26624
    v_mfma_f32_32x32x16_bf16 v[112:127], v[36:39], v[184:187], v[112:127]
    ds_read_b64_tr_b16 v[20:21], v8 offset:24576
    ds_read_b64_tr_b16 v[22:23], v8 offset:26624
    v_mfma_f32_32x32x16_bf16 v[96:111], v[40:43], v[188:191], v[96:111]
    ds_read_b64_tr_b16 v[24:25], v7 offset:25600
    ds_read_b64_tr_b16 v[26:27], v7 offset:27648
    v_mfma_f32_32x32x16_bf16 v[112:127], v[44:47], v[188:191], v[112:127]
    ds_read_b64_tr_b16 v[28:29], v8 offset:25600
    ds_read_b64_tr_b16 v[30:31], v8 offset:27648
    s_waitcnt lgkmcnt(8)
    s_waitcnt vmcnt(6)
    v_mfma_f32_32x32x16_bf16 v[96:111], v[48:51], v[128:131], v[96:111]
    v_add_u32 v7, 0, v5
    v_add_u32 v8, 0, v6
    ds_read_b64_tr_b16 v[32:33], v7 offset:0
    v_mfma_f32_32x32x16_bf16 v[112:127], v[52:55], v[128:131], v[112:127]
    ds_read_b64_tr_b16 v[34:35], v7 offset:2048
    ds_read_b64_tr_b16 v[36:37], v8 offset:0
    ds_read_b64_tr_b16 v[38:39], v8 offset:2048
    v_mfma_f32_32x32x16_bf16 v[96:111], v[56:59], v[132:135], v[96:111]
    ds_read_b64_tr_b16 v[40:41], v7 offset:1024
    ds_read_b64_tr_b16 v[42:43], v7 offset:3072
    v_mfma_f32_32x32x16_bf16 v[112:127], v[60:63], v[132:135], v[112:127]
    ds_read_b64_tr_b16 v[44:45], v8 offset:1024
    ds_read_b64_tr_b16 v[46:47], v8 offset:3072
    s_waitcnt lgkmcnt(8)
    s_waitcnt vmcnt(4)
    v_mfma_f32_32x32x16_bf16 v[96:111], v[16:19], v[136:139], v[96:111]
    ds_read_b64_tr_b16 v[48:49], v7 offset:8192
    ds_read_b64_tr_b16 v[50:51], v7 offset:10240
    v_mfma_f32_32x32x16_bf16 v[112:127], v[20:23], v[136:139], v[112:127]
    ds_read_b64_tr_b16 v[52:53], v8 offset:8192
    ds_read_b64_tr_b16 v[54:55], v8 offset:10240
    v_mfma_f32_32x32x16_bf16 v[96:111], v[24:27], v[140:143], v[96:111]
    ds_read_b64_tr_b16 v[56:57], v7 offset:9216
    ds_read_b64_tr_b16 v[58:59], v7 offset:11264
    v_mfma_f32_32x32x16_bf16 v[112:127], v[28:31], v[140:143], v[112:127]
    ds_read_b64_tr_b16 v[60:61], v8 offset:9216
    ds_read_b64_tr_b16 v[62:63], v8 offset:11264
    s_waitcnt lgkmcnt(8)
    s_waitcnt vmcnt(2)
    v_mfma_f32_32x32x16_bf16 v[96:111], v[32:35], v[144:147], v[96:111]
    v_mfma_f32_32x32x16_bf16 v[96:111], v[40:43], v[148:151], v[96:111]
    s_waitcnt lgkmcnt(0)
    s_waitcnt vmcnt(0)
    v_mfma_f32_32x32x16_bf16 v[96:111], v[48:51], v[152:155], v[96:111]
    v_mfma_f32_32x32x16_bf16 v[96:111], v[56:59], v[156:159], v[96:111]
    v_mfma_f32_32x32x16_bf16 v[112:127], v[36:39], v[144:147], v[112:127]
    s_nop 10
    ds_write_b128 v9, v[96:99] offset:33792
    v_mfma_f32_32x32x16_bf16 v[112:127], v[44:47], v[148:151], v[112:127]
    ds_write_b128 v9, v[100:103] offset:34848
    v_mfma_f32_32x32x16_bf16 v[112:127], v[52:55], v[152:155], v[112:127]
    ds_write_b128 v9, v[104:107] offset:35904
    ds_write_b128 v9, v[108:111] offset:36960
    v_mfma_f32_32x32x16_bf16 v[112:127], v[60:63], v[156:159], v[112:127]
    s_nop 11
    ds_write_b128 v9, v[112:115] offset:38016
    ds_write_b128 v9, v[116:119] offset:39072
    ds_write_b128 v9, v[120:123] offset:40128
    ds_write_b128 v9, v[124:127] offset:41184
    s_waitcnt lgkmcnt(0)
    s_barrier
    s_endpgm
K_EXIT:
    s_endpgm
CODE_END:
.section .rodata,"a"
.p2align 6
.amdhsa_kernel recurrent_scan__sliding_local_dilated__glu_gated_bilinear__prompt_kernel
  .amdhsa_next_free_vgpr 256
  .amdhsa_next_free_sgpr 80
  .amdhsa_accum_offset 256
  .amdhsa_group_segment_fixed_size 0
  .amdhsa_kernarg_size 80
  .amdhsa_user_sgpr_count 2
  .amdhsa_user_sgpr_kernarg_segment_ptr 1
  .amdhsa_system_sgpr_workgroup_id_x 1
.end_amdhsa_kernel
```
